```python
import torch

def _softmax(x, axis=-1):
    return torch.softmax(x, dim=axis)
def _gelu(x):
    return torch.nn.functional.gelu(x, approximate="tanh")
def _silu(x):
    return torch.nn.functional.silu(x)
def _sigmoid(x):
    return torch.sigmoid(x)
def _layernorm(x, axis=-1, eps=1e-5):
    m = x.mean(dim=axis, keepdim=True)
    v = x.var(dim=axis, keepdim=True, unbiased=False)
    return (x - m) / torch.sqrt(v + eps)
def _scatter_add(tgt, idx, src, axis=0):
    return tgt.clone().index_add_(axis, idx, src)
def _segment_sum(src, seg, n):
    out = torch.zeros((n,) + src.shape[1:], dtype=src.dtype)
    return out.index_add_(0, seg, src)
def _pad(x, pw):
    flat = tuple(v for pair in reversed(pw) for v in pair)
    return torch.nn.functional.pad(x, flat)

kernel_name = 'standalone__gqa_softmax__near_ridge'

def setup_inputs():

    _w = (lambda a: (lambda t: t.to(torch.bfloat16) if t.is_floating_point() else t)(torch.as_tensor(a)))
    B, Hq, Hkv, Sq, Sk, D = 8, 32, 32, 432, 1024, 192
    return {
        "q": _w((lambda *s: torch.randn(*s, dtype=torch.bfloat16) * 0.8)(B, Hq, Sq, D)),
        "k": _w((lambda *s: torch.randn(*s, dtype=torch.bfloat16) * 0.8)(B, Hkv, Sk, D)),
        "v": _w((lambda *s: torch.randn(*s, dtype=torch.bfloat16) * 0.05)(B, Hkv, Sk, D)),
    }

def reference(q, k, v):
    B, Hq, Sq, D = q.shape
    Hkv = k.shape[1]
    rep = Hq // Hkv
    k = (lambda x, n, axis: torch.repeat_interleave(x, n, dim=axis))(k, rep, axis=1)
    v = (lambda x, n, axis: torch.repeat_interleave(x, n, dim=axis))(v, rep, axis=1)
    scale = D ** -0.5
    scores = torch.einsum("bhqd,bhkd->bhqk", q, k) * scale
    p = _softmax(scores, axis=-1)
    return torch.einsum("bhqk,bhkd->bhqd", p, v)
```

```asm
; @launch grid=(256,1,1) block=(256,1,1) lds=161280
.amdgcn_target "amdgcn-amd-amdhsa--gfx950"
.text
.globl standalone__gqa_softmax__near_ridge_kernel
.p2align 8
.type standalone__gqa_softmax__near_ridge_kernel,@function
standalone__gqa_softmax__near_ridge_kernel:
    s_cmp_ge_u32 s2, 256
    s_cbranch_scc1 L_end
    s_load_dwordx4 s[52:55], s[0:1], 0
    s_load_dwordx4 s[56:59], s[0:1], 16
    v_lshrrev_b32 v152, 6, v0
    v_and_b32 v156, 63, v0
    v_readfirstlane_b32 s3, v152
    s_getpc_b64 s[72:73]
    v_lshlrev_b32 v2, 7, v0
    v_min_u32 v2, 0x7164, v2
    v_mov_b32 v3, s73
    v_add_co_u32 v2, vcc, s72, v2
    s_nop 1
    v_addc_co_u32 v3, vcc, 0, v3, vcc
    global_load_dword a255, v[2:3], off
    s_and_b32 s50, s2, 7
    s_lshr_b32 s42, s2, 4
    s_lshl_b32 s42, s42, 3
    s_or_b32 s50, s50, s42
    s_bfe_u32 s51, s2, 0x10003
    s_mul_i32 s43, s3, 3072
    v_lshrrev_b32 v152, 3, v156
    v_add_u32 v153, 0, v152
    v_mul_u32_u24 v153, 43, v153
    v_lshrrev_b32 v153, 7, v153
    v_and_b32 v153, 6, v153
    v_xor_b32 v153, v153, v156
    v_lshlrev_b32 v242, 4, v153
    v_add_u32 v153, 8, v152
    v_mul_u32_u24 v153, 43, v153
    v_lshrrev_b32 v153, 7, v153
    v_and_b32 v153, 6, v153
    v_xor_b32 v153, v153, v156
    v_lshlrev_b32 v246, 4, v153
    v_add_u32 v153, 16, v152
    v_mul_u32_u24 v153, 43, v153
    v_lshrrev_b32 v153, 7, v153
    v_and_b32 v153, 6, v153
    v_xor_b32 v153, v153, v156
    v_lshlrev_b32 v253, 4, v153
    v_and_b32 v152, 15, v156
    v_mul_u32_u24 v152, 384, v152
    v_lshrrev_b32 v153, 4, v156
    v_lshl_add_u32 v243, v153, 4, v152
    v_lshlrev_b32 v245, 4, v156
    s_mul_i32 s35, s51, 14
    s_lshr_b32 s42, s3, 1
    s_mul_i32 s42, s42, 7
    s_add_u32 s35, s35, s42
    s_and_b32 s41, s3, 1
    s_mul_i32 s42, s41, 3
    s_add_u32 s32, s35, s42
    s_add_u32 s35, s35, 6
    s_mul_i32 s32, s32, 6144
    s_mul_i32 s35, s35, 6144
    s_add_u32 s33, s32, 6144
    s_add_u32 s34, s32, 12288
    s_lshl_b32 s66, s43, 2
    s_add_u32 s66, s66, 49152
    s_add_u32 s67, s66, 6144
    s_lshr_b32 s42, s3, 1
    s_mul_i32 s68, s42, 24576
    s_mul_i32 s31, s41, 6144
    s_add_u32 s68, s68, s31
    s_add_u32 s68, s68, 98304
    s_mul_i32 s69, s42, 6144
    s_add_u32 s69, s69, 148480
    s_mul_i32 s31, s41, 3072
    s_add_u32 s64, s35, s31
    s_add_u32 s65, s69, s31
    s_mul_i32 s42, s50, 786432
    s_mul_i32 s31, s50, 331776
    s_mov_b32 s6, 786432
    s_mov_b32 s7, 0x20000
    s_mov_b32 s14, 165888
    s_mov_b32 s15, 0x20000
    s_add_u32 s40, s43, 98304
    s_mov_b32 s36, s43
    s_add_u32 s95, s32, 3072
    s_add_u32 s96, s33, 3072
    s_add_u32 s97, s34, 3072
    s_waitcnt lgkmcnt(0)
    s_add_u32 s4, s54, s42
    s_addc_u32 s5, s55, 0
    s_add_u32 s12, s52, s31
    s_addc_u32 s13, s53, 0
    s_add_u32 m0, s40, 12288
    s_nop 0
    buffer_load_dwordx4 v242, s[4:7], s36 offen offset:0 nt lds
    buffer_load_dwordx4 v246, s[4:7], s36 offen offset:1024 nt lds
    buffer_load_dwordx4 v253, s[4:7], s36 offen offset:2048 nt lds
    s_add_u32 s37, s43, 12288
    s_add_u32 m0, s43, 0
    s_nop 0
    buffer_load_dwordx4 v242, s[4:7], s37 offen offset:0 nt lds
    buffer_load_dwordx4 v246, s[4:7], s37 offen offset:1024 nt lds
    buffer_load_dwordx4 v253, s[4:7], s37 offen offset:2048 nt lds
    s_add_u32 m0, s66, 0
    s_nop 0
    buffer_load_dwordx4 v242, s[12:15], s32 offen offset:0 nt lds
    s_add_u32 m0, s66, 0
    s_nop 0
    buffer_load_dwordx4 v246, s[12:15], s32 offen offset:1024 nt lds
    s_add_u32 m0, s66, 0
    s_nop 0
    buffer_load_dwordx4 v253, s[12:15], s32 offen offset:2048 nt lds
    s_add_u32 m0, s66, 3072
    s_nop 0
    buffer_load_dwordx4 v242, s[12:15], s95 offen offset:0 nt lds
    s_add_u32 s8, s56, s42
    s_addc_u32 s9, s57, 0
    s_mov_b32 s10, 786432
    s_mov_b32 s11, 0x20000
    s_add_u32 s20, s58, s31
    s_addc_u32 s21, s59, 0
    s_mov_b32 s22, 165888
    s_mov_b32 s23, 0x20000
    s_add_u32 s16, s12, 165888
    s_addc_u32 s17, s13, 0
    s_mov_b32 s18, 165888
    s_mov_b32 s19, 0x20000
    s_add_u32 s24, s20, 165888
    s_addc_u32 s25, s21, 0
    s_mov_b32 s26, 165888
    s_mov_b32 s27, 0x20000
    s_mov_b32 s48, 0x5f800000
    s_add_u32 s37, s43, 12288
    s_add_u32 s52, s4, 12288
    s_addc_u32 s53, s5, 0
    s_cmp_eq_u32 s51, s51
    s_cselect_b32 s72, s52, s8
    s_cselect_b32 s73, s53, s9
    s_cselect_b32 s74, 774144, s6
    s_cselect_b32 s84, s8, s52
    s_cselect_b32 s85, s9, s53
    s_cselect_b32 s86, s6, 774144
    s_cselect_b32 s70, 0, 24576
    s_cselect_b32 s71, 24576, 0
    s_mov_b32 s75, 0x20000
    s_mov_b32 s87, 0x20000
    s_add_u32 s70, s70, s43
    s_add_u32 s71, s71, s43
    s_mov_b32 s40, s70
    s_mov_b32 s38, s71
    s_mov_b32 s39, 0
    v_and_b32 v152, 15, v156
    v_mul_u32_u24 v152, 384, v152
    s_add_u32 m0, s66, 3072
    s_nop 0
    buffer_load_dwordx4 v246, s[12:15], s95 offen offset:1024 nt lds
    s_add_u32 m0, s66, 3072
    s_nop 0
    buffer_load_dwordx4 v253, s[12:15], s95 offen offset:2048 nt lds
    v_lshrrev_b32 v153, 4, v156
    v_and_b32 v154, 6, v156
    v_xor_b32 v153, v153, v154
    v_lshl_add_u32 v152, v153, 4, v152
    v_add_u32 v236, s39, v152
    v_xor_b32 v237, 64, v236
    v_lshrrev_b32 v153, 2, v156
    v_mul_u32_u24 v152, 384, v153
    v_and_b32 v153, 6, v153
    v_bfe_u32 v154, v156, 1, 1
    v_xor_b32 v153, v153, v154
    v_lshl_add_u32 v152, v153, 4, v152
    v_and_b32 v154, 1, v156
    v_lshl_add_u32 v152, v154, 3, v152
    v_add_u32 v238, s39, v152
    v_xor_b32 v239, 32, v238
    v_xor_b32 v240, 64, v238
    v_xor_b32 v241, 96, v238
    s_lshl_b32 s100, s43, 1
    s_xor_b32 s101, s3, 1
    s_mul_i32 s101, s101, 6144
    s_mul_i32 s99, s41, 6400
    s_lshr_b32 s52, s3, 1
    s_mul_i32 s53, s52, 123904
    s_add_u32 s99, s99, s53
    s_add_u32 m0, s67, 0
    s_nop 0
    buffer_load_dwordx4 v242, s[12:15], s33 offen offset:0 nt lds
    s_add_u32 m0, s67, 0
    s_nop 0
    buffer_load_dwordx4 v246, s[12:15], s33 offen offset:1024 nt lds
    s_add_u32 s99, s99, 24576
    s_mul_i32 s52, s52, 12288
    s_sub_u32 s52, s52, s99
    s_mul_i32 s53, s41, 192
    s_add_u32 s49, s52, s53
    s_mul_i32 s53, s41, 3200
    s_add_u32 s30, s52, s53
    s_mov_b32 s98, s64
    s_mul_i32 s93, s41, 192
    s_add_u32 s93, s93, s35
    v_and_b32 v244, 0xffffffcf, v243
    v_and_b32 v152, 16, v243
    v_lshl_add_u32 v244, v152, 1, v244
    v_and_b32 v152, 32, v243
    v_lshrrev_b32 v152, 1, v152
    v_add_u32 v244, v244, v152
    s_lshl_b32 s53, s3, 8
    s_add_u32 s53, s53, 147456
    v_lshl_add_u32 v247, v156, 2, s53
    v_mov_b32 v212, 0
    v_mov_b32 v213, 0
    v_mov_b32 v214, 0
    v_mov_b32 v215, 0
    s_mov_b32 s42, 49152
    s_mov_b32 s31, 98304
    s_add_u32 m0, s67, 0
    s_nop 0
    buffer_load_dwordx4 v253, s[12:15], s33 offen offset:2048 nt lds
    s_add_u32 m0, s67, 3072
    s_nop 0
    buffer_load_dwordx4 v242, s[12:15], s96 offen offset:0 nt lds
    s_mov_b32 s44, 0x3dd53b95
    s_mov_b32 s28, 0xbdd53b95
    s_mov_b32 s29, 0x2b800000
    s_mov_b64 s[78:79], 0
    s_mov_b32 s46, 0
    s_mov_b32 s47, 0
    s_mov_b32 s45, 0
    s_mov_b64 vcc, 0
    v_mov_b32 v249, 0
    v_mov_b32 v250, 0
    v_mov_b32 v251, 0
    v_mov_b32 v252, 0
    s_add_u32 s53, s43, 135168
    v_add_u32 v152, s53, v245
    v_mfma_f32_32x32x16_bf16 v[0:15], v[212:215], v[212:215], 0
    v_mfma_f32_32x32x16_bf16 v[16:31], v[212:215], v[212:215], 0
    v_mfma_f32_32x32x16_bf16 v[32:47], v[212:215], v[212:215], 0
    v_mfma_f32_32x32x16_bf16 v[48:63], v[212:215], v[212:215], 0
    v_mfma_f32_32x32x16_bf16 v[64:79], v[212:215], v[212:215], 0
    v_mfma_f32_32x32x16_bf16 v[80:95], v[212:215], v[212:215], 0
    v_mfma_f32_32x32x16_bf16 v[96:111], v[212:215], v[212:215], 0
    v_mov_b32 v232, 0
    v_mov_b32 v233, 0
    v_mov_b32 v234, 0
    v_mov_b32 v235, 0
    s_add_u32 m0, s67, 3072
    s_nop 0
    buffer_load_dwordx4 v246, s[12:15], s96 offen offset:1024 nt lds
    s_add_u32 m0, s67, 3072
    s_nop 0
    buffer_load_dwordx4 v253, s[12:15], s96 offen offset:2048 nt lds
    s_add_u32 m0, s68, 0
    s_nop 0
    buffer_load_dwordx4 v242, s[12:15], s34 offen offset:0 nt lds
    s_add_u32 m0, s68, 0
    s_nop 0
    buffer_load_dwordx4 v246, s[12:15], s34 offen offset:1024 nt lds
    s_add_u32 m0, s68, 0
    s_nop 0
    buffer_load_dwordx4 v253, s[12:15], s34 offen offset:2048 nt lds
    s_add_u32 m0, s68, 3072
    s_nop 0
    buffer_load_dwordx4 v242, s[12:15], s97 offen offset:0 nt lds
    v_add_u32 v254, 110592, v236
    v_add_u32 v255, 110592, v237
    s_waitcnt vmcnt(16)
    s_barrier
    ds_read_b128 a[72:75], v254 offset:0
    ds_read_b128 a[76:79], v255 offset:0
    ds_read_b128 a[80:83], v254 offset:128
    ds_read_b128 a[84:87], v255 offset:128
    ds_read_b128 a[88:91], v254 offset:256
    ds_read_b128 a[92:95], v255 offset:256
    ds_read_b128 a[96:99], v254 offset:6144
    ds_read_b128 a[100:103], v255 offset:6144
    ds_read_b128 a[104:107], v254 offset:6272
    ds_read_b128 a[108:111], v255 offset:6272
    ds_read_b128 a[112:115], v254 offset:6400
    ds_read_b128 a[116:119], v255 offset:6400
    ds_read_b128 a[0:3], v236 offset:0
    ds_read_b128 a[4:7], v237 offset:0
    ds_read_b128 a[8:11], v236 offset:128
    ds_read_b128 a[12:15], v237 offset:128
    ds_read_b128 a[16:19], v236 offset:256
    ds_read_b128 a[20:23], v237 offset:256
    ds_read_b128 a[24:27], v236 offset:6144
    ds_read_b128 a[28:31], v237 offset:6144
    ds_read_b128 a[32:35], v236 offset:6272
    ds_read_b128 a[36:39], v237 offset:6272
    ds_read_b128 a[40:43], v236 offset:6400
    ds_read_b128 a[44:47], v237 offset:6400
    v_add_u32 v254, s66, v236
    v_add_u32 v255, s66, v237
    s_waitcnt vmcnt(10)
    ds_read_b128 a[48:51], v254 offset:0
    ds_read_b128 a[52:55], v255 offset:0
    ds_read_b128 a[56:59], v254 offset:128
    ds_read_b128 a[60:63], v255 offset:128
    ds_read_b128 a[64:67], v254 offset:256
    ds_read_b128 a[68:71], v255 offset:256
    s_waitcnt lgkmcnt(0)
    v_mfma_f32_16x16x32_bf16 v[216:219], a[72:75], a[48:51], 0
    v_bfe_u32 v178, v247, 2, 1
    v_mfma_f32_16x16x32_bf16 v[216:219], a[76:79], a[52:55], v[216:219]
    v_lshlrev_b32 v178, 4, v178
    v_mov_b32 v179, 0x3dd5
    v_mfma_f32_16x16x32_bf16 v[216:219], a[80:83], a[56:59], v[216:219]
    v_lshlrev_b32 v128, v178, v179
    v_mov_b32 v179, 0x38ee
    v_mfma_f32_16x16x32_bf16 v[216:219], a[84:87], a[60:63], v[216:219]
    v_lshlrev_b32 v130, v178, v179
    v_bfe_i32 v178, v247, 3, 1
    v_mfma_f32_16x16x32_bf16 v[216:219], a[88:91], a[64:67], v[216:219]
    v_and_b32 v129, v178, v128
    v_and_b32 v131, v178, v130
    v_mfma_f32_16x16x32_bf16 v[216:219], a[92:95], a[68:71], v[216:219]
    v_xor_b32 v128, v128, v129
    v_xor_b32 v130, v130, v131
    s_nop 0
    v_mfma_f32_4x4x4_16b_bf16 v[112:115], v[128:129], a[48:49], 0
    v_mfma_f32_4x4x4_16b_bf16 v[116:119], v[128:129], a[50:51], 0
    s_nop 0
    v_mfma_f32_4x4x4_16b_bf16 v[112:115], v[130:131], a[48:49], v[112:115]
    v_mfma_f32_4x4x4_16b_bf16 v[120:123], v[128:129], a[52:53], 0
    v_mfma_f32_4x4x4_16b_bf16 v[116:119], v[130:131], a[50:51], v[116:119]
    v_max3_f32 v176, v216, v217, v218
    s_add_u32 m0, s68, 3072
    s_nop 0
    buffer_load_dwordx4 v246, s[12:15], s97 offen offset:1024 nt lds
    s_add_u32 m0, s68, 3072
    s_nop 0
    buffer_load_dwordx4 v253, s[12:15], s97 offen offset:2048 nt lds
    v_mfma_f32_4x4x4_16b_bf16 v[124:127], v[128:129], a[54:55], 0
    v_cvt_pk_bf16_f32 v132, v112, v113
    v_mfma_f32_4x4x4_16b_bf16 v[120:123], v[130:131], a[52:53], v[120:123]
    v_cvt_pk_bf16_f32 v133, v114, v115
    v_max_f32 v176, v176, v219
    v_mfma_f32_4x4x4_16b_bf16 v[112:115], v[128:129], a[56:57], 0
    v_cvt_pk_bf16_f32 v134, v116, v117
    v_mfma_f32_4x4x4_16b_bf16 v[124:127], v[130:131], a[54:55], v[124:127]
    v_cvt_pk_bf16_f32 v135, v118, v119
    v_accvgpr_write_b32 a144, v132
    v_accvgpr_write_b32 a145, v133
    v_mov_b32 v177, v176
    v_mfma_f32_4x4x4_16b_bf16 v[116:119], v[128:129], a[58:59], 0
    v_cvt_pk_bf16_f32 v132, v120, v121
    v_mfma_f32_4x4x4_16b_bf16 v[112:115], v[130:131], a[56:57], v[112:115]
    v_cvt_pk_bf16_f32 v133, v122, v123
    v_accvgpr_write_b32 a146, v134
    v_accvgpr_write_b32 a147, v135
    v_permlane32_swap_b32 v176, v177
    s_nop 1
    v_mfma_f32_4x4x4_16b_bf16 v[120:123], v[128:129], a[60:61], 0
    v_cvt_pk_bf16_f32 v134, v124, v125
    v_mfma_f32_4x4x4_16b_bf16 v[116:119], v[130:131], a[58:59], v[116:119]
    v_cvt_pk_bf16_f32 v135, v126, v127
    v_accvgpr_write_b32 a148, v132
    v_accvgpr_write_b32 a149, v133
    v_max_f32 v176, v176, v177
    v_mov_b32 v177, v176
    s_add_u32 m0, s65, 0
    s_nop 0
    buffer_load_dwordx4 v242, s[12:15], s64 offen offset:0 nt lds
    v_mfma_f32_4x4x4_16b_bf16 v[124:127], v[128:129], a[62:63], 0
    v_cvt_pk_bf16_f32 v132, v112, v113
    v_mfma_f32_4x4x4_16b_bf16 v[120:123], v[130:131], a[60:61], v[120:123]
    v_cvt_pk_bf16_f32 v133, v114, v115
    v_accvgpr_write_b32 a150, v134
    v_accvgpr_write_b32 a151, v135
    v_permlane16_swap_b32 v176, v177
    s_nop 1
    v_mfma_f32_4x4x4_16b_bf16 v[112:115], v[128:129], a[64:65], 0
    v_cvt_pk_bf16_f32 v134, v116, v117
    v_mfma_f32_4x4x4_16b_bf16 v[124:127], v[130:131], a[62:63], v[124:127]
    v_cvt_pk_bf16_f32 v135, v118, v119
    v_accvgpr_write_b32 a152, v132
    v_accvgpr_write_b32 a153, v133
    v_max_f32 v176, v176, v177
    v_mfma_f32_4x4x4_16b_bf16 v[116:119], v[128:129], a[66:67], 0
    v_cvt_pk_bf16_f32 v132, v120, v121
    v_mfma_f32_4x4x4_16b_bf16 v[112:115], v[130:131], a[64:65], v[112:115]
    v_cvt_pk_bf16_f32 v133, v122, v123
    v_accvgpr_write_b32 a154, v134
    v_accvgpr_write_b32 a155, v135
    v_mul_f32 v216, s28, v176
    v_mfma_f32_4x4x4_16b_bf16 v[120:123], v[128:129], a[68:69], 0
    v_cvt_pk_bf16_f32 v134, v124, v125
    v_mfma_f32_4x4x4_16b_bf16 v[116:119], v[130:131], a[66:67], v[116:119]
    v_cvt_pk_bf16_f32 v135, v126, v127
    v_accvgpr_write_b32 a156, v132
    v_accvgpr_write_b32 a157, v133
    v_mul_f32 v217, s28, v176
    s_add_u32 m0, s65, 0
    s_nop 0
    buffer_load_dwordx4 v246, s[12:15], s64 offen offset:1024 nt lds
    v_mfma_f32_4x4x4_16b_bf16 v[124:127], v[128:129], a[70:71], 0
    v_cvt_pk_bf16_f32 v132, v112, v113
    v_mfma_f32_4x4x4_16b_bf16 v[120:123], v[130:131], a[68:69], v[120:123]
    v_cvt_pk_bf16_f32 v133, v114, v115
    v_accvgpr_write_b32 a158, v134
    v_accvgpr_write_b32 a159, v135
    v_mul_f32 v218, s28, v176
    v_mul_f32 v219, s28, v176
    v_cvt_pk_bf16_f32 v134, v116, v117
    v_mfma_f32_4x4x4_16b_bf16 v[124:127], v[130:131], a[70:71], v[124:127]
    v_cvt_pk_bf16_f32 v135, v118, v119
    v_accvgpr_write_b32 a160, v132
    v_accvgpr_write_b32 a161, v133
    v_cvt_pk_bf16_f32 v132, v120, v121
    v_cvt_pk_bf16_f32 v133, v122, v123
    v_accvgpr_write_b32 a162, v134
    v_accvgpr_write_b32 a163, v135
    v_cvt_pk_bf16_f32 v134, v124, v125
    v_cvt_pk_bf16_f32 v135, v126, v127
    v_accvgpr_write_b32 a164, v132
    v_accvgpr_write_b32 a165, v133
    s_add_u32 m0, s65, 0
    s_nop 0
    buffer_load_dwordx4 v253, s[12:15], s64 offen offset:2048 nt lds
    v_accvgpr_write_b32 a166, v134
    v_accvgpr_write_b32 a167, v135
    v_mfma_f32_16x16x32_bf16 v[152:155], a[72:75], a[144:147], v[216:219]
    v_mfma_f32_16x16x32_bf16 v[156:159], a[96:99], a[144:147], v[216:219]
    v_mfma_f32_16x16x32_bf16 v[152:155], a[76:79], a[148:151], v[152:155]
    v_mfma_f32_16x16x32_bf16 v[156:159], a[100:103], a[148:151], v[156:159]
    v_mfma_f32_16x16x32_bf16 v[152:155], a[80:83], a[152:155], v[152:155]
    v_mfma_f32_16x16x32_bf16 v[156:159], a[104:107], a[152:155], v[156:159]
    v_mfma_f32_16x16x32_bf16 v[152:155], a[84:87], a[156:159], v[152:155]
    v_mfma_f32_16x16x32_bf16 v[156:159], a[108:111], a[156:159], v[156:159]
    v_mfma_f32_16x16x32_bf16 v[152:155], a[88:91], a[160:163], v[152:155]
    v_mfma_f32_16x16x32_bf16 v[156:159], a[112:115], a[160:163], v[156:159]
    v_mfma_f32_16x16x32_bf16 v[152:155], a[92:95], a[164:167], v[152:155]
    v_mfma_f32_16x16x32_bf16 v[156:159], a[116:119], a[164:167], v[156:159]
    v_mfma_f32_16x16x32_bf16 v[184:187], a[0:3], a[144:147], v[216:219]
    v_mfma_f32_16x16x32_bf16 v[188:191], a[24:27], a[144:147], v[216:219]
    v_mfma_f32_16x16x32_bf16 v[184:187], a[4:7], a[148:151], v[184:187]
    v_mfma_f32_16x16x32_bf16 v[188:191], a[28:31], a[148:151], v[188:191]
    v_mfma_f32_16x16x32_bf16 v[184:187], a[8:11], a[152:155], v[184:187]
    v_mfma_f32_16x16x32_bf16 v[188:191], a[32:35], a[152:155], v[188:191]
    s_nop 0
    v_exp_f32 v152, v152
    v_exp_f32 v153, v153
    v_mfma_f32_16x16x32_bf16 v[184:187], a[12:15], a[156:159], v[184:187]
    v_exp_f32 v154, v154
    v_exp_f32 v155, v155
    v_mfma_f32_16x16x32_bf16 v[188:191], a[36:39], a[156:159], v[188:191]
    v_exp_f32 v156, v156
    v_exp_f32 v157, v157
    v_mfma_f32_16x16x32_bf16 v[184:187], a[16:19], a[160:163], v[184:187]
    v_exp_f32 v158, v158
    v_exp_f32 v159, v159
    v_add_f32 v232, v232, v152
    v_mfma_f32_16x16x32_bf16 v[188:191], a[40:43], a[160:163], v[188:191]
    v_add_f32 v232, v232, v153
    v_cvt_pk_bf16_f32 v152, v152, v153
    v_mfma_f32_16x16x32_bf16 v[184:187], a[20:23], a[164:167], v[184:187]
    v_add_f32 v232, v232, v154
    v_add_f32 v232, v232, v155
    v_mfma_f32_16x16x32_bf16 v[188:191], a[44:47], a[164:167], v[188:191]
    v_cvt_pk_bf16_f32 v153, v154, v155
    v_cvt_pk_bf16_f32 v154, v156, v157
    v_cvt_pk_bf16_f32 v155, v158, v159
    v_add_u32 v254, s67, v236
    v_add_u32 v255, s67, v237
    s_waitcnt vmcnt(9)
    ds_read_b128 a[48:51], v254 offset:0
    ds_read_b128 a[52:55], v255 offset:0
    ds_read_b128 a[56:59], v254 offset:128
    ds_read_b128 a[60:63], v255 offset:128
    ds_read_b128 a[64:67], v254 offset:256
    ds_read_b128 a[68:71], v255 offset:256
    s_waitcnt lgkmcnt(0)
    v_mfma_f32_16x16x32_bf16 v[220:223], a[72:75], a[48:51], 0
    v_mfma_f32_16x16x32_bf16 v[220:223], a[76:79], a[52:55], v[220:223]
    v_mfma_f32_16x16x32_bf16 v[220:223], a[80:83], a[56:59], v[220:223]
    v_mfma_f32_16x16x32_bf16 v[220:223], a[84:87], a[60:63], v[220:223]
    v_mfma_f32_16x16x32_bf16 v[220:223], a[88:91], a[64:67], v[220:223]
    v_mfma_f32_16x16x32_bf16 v[220:223], a[92:95], a[68:71], v[220:223]
    v_mfma_f32_4x4x4_16b_bf16 v[112:115], v[128:129], a[48:49], 0
    v_mfma_f32_4x4x4_16b_bf16 v[116:119], v[128:129], a[50:51], 0
    s_nop 0
    v_mfma_f32_4x4x4_16b_bf16 v[112:115], v[130:131], a[48:49], v[112:115]
    s_add_u32 m0, s38, 0
    s_nop 0
    buffer_load_dwordx4 v242, s[84:87], s36 offen offset:0 nt lds
    v_mfma_f32_4x4x4_16b_bf16 v[120:123], v[128:129], a[52:53], 0
    v_mfma_f32_4x4x4_16b_bf16 v[116:119], v[130:131], a[50:51], v[116:119]
    v_max3_f32 v176, v220, v221, v222
    v_mfma_f32_4x4x4_16b_bf16 v[124:127], v[128:129], a[54:55], 0
    v_cvt_pk_bf16_f32 v132, v112, v113
    v_mfma_f32_4x4x4_16b_bf16 v[120:123], v[130:131], a[52:53], v[120:123]
    v_cvt_pk_bf16_f32 v133, v114, v115
    v_max_f32 v176, v176, v223
    v_mfma_f32_4x4x4_16b_bf16 v[112:115], v[128:129], a[56:57], 0
    v_cvt_pk_bf16_f32 v134, v116, v117
    v_mfma_f32_4x4x4_16b_bf16 v[124:127], v[130:131], a[54:55], v[124:127]
    v_cvt_pk_bf16_f32 v135, v118, v119
    v_accvgpr_write_b32 a168, v132
    v_accvgpr_write_b32 a169, v133
    v_mov_b32 v177, v176
    s_add_u32 m0, s38, 0
    s_nop 0
    buffer_load_dwordx4 v246, s[84:87], s36 offen offset:1024 nt lds
    v_mfma_f32_4x4x4_16b_bf16 v[116:119], v[128:129], a[58:59], 0
    v_cvt_pk_bf16_f32 v132, v120, v121
    v_mfma_f32_4x4x4_16b_bf16 v[112:115], v[130:131], a[56:57], v[112:115]
    v_cvt_pk_bf16_f32 v133, v122, v123
    v_accvgpr_write_b32 a170, v134
    v_accvgpr_write_b32 a171, v135
    v_permlane32_swap_b32 v176, v177
    s_nop 1
    v_mfma_f32_4x4x4_16b_bf16 v[120:123], v[128:129], a[60:61], 0
    v_cvt_pk_bf16_f32 v134, v124, v125
    v_mfma_f32_4x4x4_16b_bf16 v[116:119], v[130:131], a[58:59], v[116:119]
    v_cvt_pk_bf16_f32 v135, v126, v127
    v_accvgpr_write_b32 a172, v132
    v_accvgpr_write_b32 a173, v133
    v_max_f32 v176, v176, v177
    v_mov_b32 v177, v176
    v_mfma_f32_4x4x4_16b_bf16 v[124:127], v[128:129], a[62:63], 0
    v_cvt_pk_bf16_f32 v132, v112, v113
    v_mfma_f32_4x4x4_16b_bf16 v[120:123], v[130:131], a[60:61], v[120:123]
    v_cvt_pk_bf16_f32 v133, v114, v115
    v_accvgpr_write_b32 a174, v134
    v_accvgpr_write_b32 a175, v135
    v_permlane16_swap_b32 v176, v177
    s_add_u32 m0, s38, 0
    s_nop 0
    buffer_load_dwordx4 v253, s[84:87], s36 offen offset:2048 nt lds
    v_mfma_f32_4x4x4_16b_bf16 v[112:115], v[128:129], a[64:65], 0
    v_cvt_pk_bf16_f32 v134, v116, v117
    v_mfma_f32_4x4x4_16b_bf16 v[124:127], v[130:131], a[62:63], v[124:127]
    v_cvt_pk_bf16_f32 v135, v118, v119
    v_accvgpr_write_b32 a176, v132
    v_accvgpr_write_b32 a177, v133
    v_max_f32 v176, v176, v177
    v_mfma_f32_4x4x4_16b_bf16 v[116:119], v[128:129], a[66:67], 0
    v_cvt_pk_bf16_f32 v132, v120, v121
    v_mfma_f32_4x4x4_16b_bf16 v[112:115], v[130:131], a[64:65], v[112:115]
    v_cvt_pk_bf16_f32 v133, v122, v123
    v_accvgpr_write_b32 a178, v134
    v_accvgpr_write_b32 a179, v135
    v_mul_f32 v220, s28, v176
    v_mfma_f32_4x4x4_16b_bf16 v[120:123], v[128:129], a[68:69], 0
    v_cvt_pk_bf16_f32 v134, v124, v125
    v_mfma_f32_4x4x4_16b_bf16 v[116:119], v[130:131], a[66:67], v[116:119]
    v_cvt_pk_bf16_f32 v135, v126, v127
    v_accvgpr_write_b32 a180, v132
    v_accvgpr_write_b32 a181, v133
    v_mul_f32 v221, s28, v176
    s_add_u32 m0, s40, 12288
    s_nop 0
    buffer_load_dwordx4 v242, s[72:75], s37 offen offset:0 nt lds
    v_mfma_f32_4x4x4_16b_bf16 v[124:127], v[128:129], a[70:71], 0
    v_cvt_pk_bf16_f32 v132, v112, v113
    v_mfma_f32_4x4x4_16b_bf16 v[120:123], v[130:131], a[68:69], v[120:123]
    v_cvt_pk_bf16_f32 v133, v114, v115
    v_accvgpr_write_b32 a182, v134
    v_accvgpr_write_b32 a183, v135
    v_mul_f32 v222, s28, v176
    v_mul_f32 v223, s28, v176
    v_cvt_pk_bf16_f32 v134, v116, v117
    v_mfma_f32_4x4x4_16b_bf16 v[124:127], v[130:131], a[70:71], v[124:127]
    v_cvt_pk_bf16_f32 v135, v118, v119
    v_accvgpr_write_b32 a184, v132
    v_accvgpr_write_b32 a185, v133
    v_cvt_pk_bf16_f32 v132, v120, v121
    v_cvt_pk_bf16_f32 v133, v122, v123
    v_accvgpr_write_b32 a186, v134
    v_accvgpr_write_b32 a187, v135
    s_add_u32 m0, s40, 12288
    s_nop 0
    buffer_load_dwordx4 v246, s[72:75], s37 offen offset:1024 nt lds
    v_cvt_pk_bf16_f32 v134, v124, v125
    v_cvt_pk_bf16_f32 v135, v126, v127
    v_accvgpr_write_b32 a188, v132
    v_accvgpr_write_b32 a189, v133
    v_accvgpr_write_b32 a190, v134
    v_accvgpr_write_b32 a191, v135
    v_mfma_f32_16x16x32_bf16 v[160:163], a[72:75], a[168:171], v[220:223]
    v_mfma_f32_16x16x32_bf16 v[164:167], a[96:99], a[168:171], v[220:223]
    v_mfma_f32_16x16x32_bf16 v[160:163], a[76:79], a[172:175], v[160:163]
    v_mfma_f32_16x16x32_bf16 v[164:167], a[100:103], a[172:175], v[164:167]
    v_mfma_f32_16x16x32_bf16 v[160:163], a[80:83], a[176:179], v[160:163]
    v_mfma_f32_16x16x32_bf16 v[164:167], a[104:107], a[176:179], v[164:167]
    v_mfma_f32_16x16x32_bf16 v[160:163], a[84:87], a[180:183], v[160:163]
    v_mfma_f32_16x16x32_bf16 v[164:167], a[108:111], a[180:183], v[164:167]
    v_mfma_f32_16x16x32_bf16 v[160:163], a[88:91], a[184:187], v[160:163]
    v_mfma_f32_16x16x32_bf16 v[164:167], a[112:115], a[184:187], v[164:167]
    v_mfma_f32_16x16x32_bf16 v[160:163], a[92:95], a[188:191], v[160:163]
    v_mfma_f32_16x16x32_bf16 v[164:167], a[116:119], a[188:191], v[164:167]
    v_mfma_f32_16x16x32_bf16 v[192:195], a[0:3], a[168:171], v[220:223]
    v_mfma_f32_16x16x32_bf16 v[196:199], a[24:27], a[168:171], v[220:223]
    v_mfma_f32_16x16x32_bf16 v[192:195], a[4:7], a[172:175], v[192:195]
    v_mfma_f32_16x16x32_bf16 v[196:199], a[28:31], a[172:175], v[196:199]
    v_mfma_f32_16x16x32_bf16 v[192:195], a[8:11], a[176:179], v[192:195]
    v_mfma_f32_16x16x32_bf16 v[196:199], a[32:35], a[176:179], v[196:199]
    s_nop 0
    v_exp_f32 v160, v160
    v_exp_f32 v161, v161
    v_mfma_f32_16x16x32_bf16 v[192:195], a[12:15], a[180:183], v[192:195]
    v_exp_f32 v162, v162
    v_exp_f32 v163, v163
    v_mfma_f32_16x16x32_bf16 v[196:199], a[36:39], a[180:183], v[196:199]
    v_exp_f32 v164, v164
    v_exp_f32 v165, v165
    v_mfma_f32_16x16x32_bf16 v[192:195], a[16:19], a[184:187], v[192:195]
    v_exp_f32 v166, v166
    v_exp_f32 v167, v167
    v_add_f32 v233, v233, v160
    v_mfma_f32_16x16x32_bf16 v[196:199], a[40:43], a[184:187], v[196:199]
    v_add_f32 v233, v233, v161
    v_cvt_pk_bf16_f32 v160, v160, v161
    v_mfma_f32_16x16x32_bf16 v[192:195], a[20:23], a[188:191], v[192:195]
    v_add_f32 v233, v233, v162
    v_add_f32 v233, v233, v163
    v_mfma_f32_16x16x32_bf16 v[196:199], a[44:47], a[188:191], v[196:199]
    v_cvt_pk_bf16_f32 v161, v162, v163
    v_cvt_pk_bf16_f32 v162, v164, v165
    v_cvt_pk_bf16_f32 v163, v166, v167
    v_add_u32 v254, s68, v236
    v_add_u32 v255, s68, v237
    s_waitcnt vmcnt(8)
    ds_read_b128 a[48:51], v254 offset:0
    ds_read_b128 a[52:55], v255 offset:0
    ds_read_b128 a[56:59], v254 offset:128
    ds_read_b128 a[60:63], v255 offset:128
    ds_read_b128 a[64:67], v254 offset:256
    ds_read_b128 a[68:71], v255 offset:256
    s_waitcnt lgkmcnt(0)
    v_mfma_f32_16x16x32_bf16 v[224:227], a[72:75], a[48:51], 0
    v_mfma_f32_16x16x32_bf16 v[224:227], a[76:79], a[52:55], v[224:227]
    v_mfma_f32_16x16x32_bf16 v[224:227], a[80:83], a[56:59], v[224:227]
    v_mfma_f32_16x16x32_bf16 v[224:227], a[84:87], a[60:63], v[224:227]
    v_mfma_f32_16x16x32_bf16 v[224:227], a[88:91], a[64:67], v[224:227]
    v_mfma_f32_16x16x32_bf16 v[224:227], a[92:95], a[68:71], v[224:227]
    v_mfma_f32_4x4x4_16b_bf16 v[112:115], v[128:129], a[48:49], 0
    v_mfma_f32_4x4x4_16b_bf16 v[116:119], v[128:129], a[50:51], 0
    s_nop 0
    v_mfma_f32_4x4x4_16b_bf16 v[112:115], v[130:131], a[48:49], v[112:115]
    s_add_u32 m0, s40, 12288
    s_nop 0
    buffer_load_dwordx4 v253, s[72:75], s37 offen offset:2048 nt lds
    v_mfma_f32_4x4x4_16b_bf16 v[120:123], v[128:129], a[52:53], 0
    v_mfma_f32_4x4x4_16b_bf16 v[116:119], v[130:131], a[50:51], v[116:119]
    v_max3_f32 v176, v224, v225, v226
    v_mfma_f32_4x4x4_16b_bf16 v[124:127], v[128:129], a[54:55], 0
    v_cvt_pk_bf16_f32 v132, v112, v113
    v_mfma_f32_4x4x4_16b_bf16 v[120:123], v[130:131], a[52:53], v[120:123]
    v_cvt_pk_bf16_f32 v133, v114, v115
    v_max_f32 v176, v176, v227
    v_mfma_f32_4x4x4_16b_bf16 v[112:115], v[128:129], a[56:57], 0
    v_cvt_pk_bf16_f32 v134, v116, v117
    v_mfma_f32_4x4x4_16b_bf16 v[124:127], v[130:131], a[54:55], v[124:127]
    v_cvt_pk_bf16_f32 v135, v118, v119
    v_accvgpr_write_b32 a192, v132
    v_accvgpr_write_b32 a193, v133
    v_mov_b32 v177, v176
    s_add_u32 m0, s38, 12288
    s_nop 0
    buffer_load_dwordx4 v242, s[84:87], s37 offen offset:0 nt lds
    v_mfma_f32_4x4x4_16b_bf16 v[116:119], v[128:129], a[58:59], 0
    v_cvt_pk_bf16_f32 v132, v120, v121
    v_mfma_f32_4x4x4_16b_bf16 v[112:115], v[130:131], a[56:57], v[112:115]
    v_cvt_pk_bf16_f32 v133, v122, v123
    v_accvgpr_write_b32 a194, v134
    v_accvgpr_write_b32 a195, v135
    v_permlane32_swap_b32 v176, v177
    s_nop 1
    v_mfma_f32_4x4x4_16b_bf16 v[120:123], v[128:129], a[60:61], 0
    v_cvt_pk_bf16_f32 v134, v124, v125
    v_mfma_f32_4x4x4_16b_bf16 v[116:119], v[130:131], a[58:59], v[116:119]
    v_cvt_pk_bf16_f32 v135, v126, v127
    v_accvgpr_write_b32 a196, v132
    v_accvgpr_write_b32 a197, v133
    v_max_f32 v176, v176, v177
    v_mov_b32 v177, v176
    v_mfma_f32_4x4x4_16b_bf16 v[124:127], v[128:129], a[62:63], 0
    v_cvt_pk_bf16_f32 v132, v112, v113
    v_mfma_f32_4x4x4_16b_bf16 v[120:123], v[130:131], a[60:61], v[120:123]
    v_cvt_pk_bf16_f32 v133, v114, v115
    v_accvgpr_write_b32 a198, v134
    v_accvgpr_write_b32 a199, v135
    v_permlane16_swap_b32 v176, v177
    s_add_u32 m0, s38, 12288
    s_nop 0
    buffer_load_dwordx4 v246, s[84:87], s37 offen offset:1024 nt lds
    v_mfma_f32_4x4x4_16b_bf16 v[112:115], v[128:129], a[64:65], 0
    v_cvt_pk_bf16_f32 v134, v116, v117
    v_mfma_f32_4x4x4_16b_bf16 v[124:127], v[130:131], a[62:63], v[124:127]
    v_cvt_pk_bf16_f32 v135, v118, v119
    v_accvgpr_write_b32 a200, v132
    v_accvgpr_write_b32 a201, v133
    v_max_f32 v176, v176, v177
    v_mfma_f32_4x4x4_16b_bf16 v[116:119], v[128:129], a[66:67], 0
    v_cvt_pk_bf16_f32 v132, v120, v121
    v_mfma_f32_4x4x4_16b_bf16 v[112:115], v[130:131], a[64:65], v[112:115]
    v_cvt_pk_bf16_f32 v133, v122, v123
    v_accvgpr_write_b32 a202, v134
    v_accvgpr_write_b32 a203, v135
    v_mul_f32 v224, s28, v176
    v_mfma_f32_4x4x4_16b_bf16 v[120:123], v[128:129], a[68:69], 0
    v_cvt_pk_bf16_f32 v134, v124, v125
    v_mfma_f32_4x4x4_16b_bf16 v[116:119], v[130:131], a[66:67], v[116:119]
    v_cvt_pk_bf16_f32 v135, v126, v127
    v_accvgpr_write_b32 a204, v132
    v_accvgpr_write_b32 a205, v133
    v_mul_f32 v225, s28, v176
    s_add_u32 m0, s38, 12288
    s_nop 0
    buffer_load_dwordx4 v253, s[84:87], s37 offen offset:2048 nt lds
    v_mfma_f32_4x4x4_16b_bf16 v[124:127], v[128:129], a[70:71], 0
    v_cvt_pk_bf16_f32 v132, v112, v113
    v_mfma_f32_4x4x4_16b_bf16 v[120:123], v[130:131], a[68:69], v[120:123]
    v_cvt_pk_bf16_f32 v133, v114, v115
    v_accvgpr_write_b32 a206, v134
    v_accvgpr_write_b32 a207, v135
    v_mul_f32 v226, s28, v176
    v_mul_f32 v227, s28, v176
    v_cvt_pk_bf16_f32 v134, v116, v117
    v_mfma_f32_4x4x4_16b_bf16 v[124:127], v[130:131], a[70:71], v[124:127]
    v_cvt_pk_bf16_f32 v135, v118, v119
    v_accvgpr_write_b32 a208, v132
    v_accvgpr_write_b32 a209, v133
    v_cvt_pk_bf16_f32 v132, v120, v121
    v_cvt_pk_bf16_f32 v133, v122, v123
    v_accvgpr_write_b32 a210, v134
    v_accvgpr_write_b32 a211, v135
    v_cvt_pk_bf16_f32 v134, v124, v125
    v_cvt_pk_bf16_f32 v135, v126, v127
    v_accvgpr_write_b32 a212, v132
    v_accvgpr_write_b32 a213, v133
    v_accvgpr_write_b32 a214, v134
    v_accvgpr_write_b32 a215, v135
    v_mfma_f32_16x16x32_bf16 v[168:171], a[72:75], a[192:195], v[224:227]
    v_mfma_f32_16x16x32_bf16 v[172:175], a[96:99], a[192:195], v[224:227]
    v_mfma_f32_16x16x32_bf16 v[168:171], a[76:79], a[196:199], v[168:171]
    v_mfma_f32_16x16x32_bf16 v[172:175], a[100:103], a[196:199], v[172:175]
    v_mfma_f32_16x16x32_bf16 v[168:171], a[80:83], a[200:203], v[168:171]
    v_mfma_f32_16x16x32_bf16 v[172:175], a[104:107], a[200:203], v[172:175]
    v_mfma_f32_16x16x32_bf16 v[168:171], a[84:87], a[204:207], v[168:171]
    v_mfma_f32_16x16x32_bf16 v[172:175], a[108:111], a[204:207], v[172:175]
    v_mfma_f32_16x16x32_bf16 v[168:171], a[88:91], a[208:211], v[168:171]
    v_mfma_f32_16x16x32_bf16 v[172:175], a[112:115], a[208:211], v[172:175]
    v_mfma_f32_16x16x32_bf16 v[168:171], a[92:95], a[212:215], v[168:171]
    v_mfma_f32_16x16x32_bf16 v[172:175], a[116:119], a[212:215], v[172:175]
    v_mfma_f32_16x16x32_bf16 v[200:203], a[0:3], a[192:195], v[224:227]
    v_mfma_f32_16x16x32_bf16 v[204:207], a[24:27], a[192:195], v[224:227]
    v_mfma_f32_16x16x32_bf16 v[200:203], a[4:7], a[196:199], v[200:203]
    v_mfma_f32_16x16x32_bf16 v[204:207], a[28:31], a[196:199], v[204:207]
    v_mfma_f32_16x16x32_bf16 v[200:203], a[8:11], a[200:203], v[200:203]
    v_mfma_f32_16x16x32_bf16 v[204:207], a[32:35], a[200:203], v[204:207]
    s_nop 0
    v_exp_f32 v168, v168
    v_exp_f32 v169, v169
    v_mfma_f32_16x16x32_bf16 v[200:203], a[12:15], a[204:207], v[200:203]
    v_exp_f32 v170, v170
    v_exp_f32 v171, v171
    v_mfma_f32_16x16x32_bf16 v[204:207], a[36:39], a[204:207], v[204:207]
    v_exp_f32 v172, v172
    v_exp_f32 v173, v173
    v_mfma_f32_16x16x32_bf16 v[200:203], a[16:19], a[208:211], v[200:203]
    v_exp_f32 v174, v174
    v_exp_f32 v175, v175
    v_add_f32 v234, v234, v168
    v_mfma_f32_16x16x32_bf16 v[204:207], a[40:43], a[208:211], v[204:207]
    v_add_f32 v234, v234, v169
    v_cvt_pk_bf16_f32 v168, v168, v169
    v_mfma_f32_16x16x32_bf16 v[200:203], a[20:23], a[212:215], v[200:203]
    v_add_f32 v234, v234, v170
    v_add_f32 v234, v234, v171
    v_mfma_f32_16x16x32_bf16 v[204:207], a[44:47], a[212:215], v[204:207]
    v_cvt_pk_bf16_f32 v169, v170, v171
    v_cvt_pk_bf16_f32 v170, v172, v173
    v_cvt_pk_bf16_f32 v171, v174, v175
    s_add_u32 s40, s70, 49152
    s_add_u32 s38, s71, 49152
    s_add_u32 s36, s36, 24576
    s_add_u32 s37, s37, 24576
    s_bitcmp1_b32 s3, 0
    s_cbranch_scc1 L_o_start
L_e_start:
    v_add_f32 v232, v232, v156
    v_add_f32 v232, v232, v157
    v_add_f32 v232, v232, v158
    v_add_f32 v232, v232, v159
    v_add_f32 v233, v233, v164
    v_add_f32 v233, v233, v165
    v_add_f32 v233, v233, v166
    v_exp_f32 v184, v184
    v_add_f32 v233, v233, v167
    v_add_f32 v234, v234, v172
    v_exp_f32 v185, v185
    v_exp_f32 v186, v186
    v_add_f32 v234, v234, v173
    v_add_f32 v234, v234, v174
    v_exp_f32 v187, v187
    v_add_f32 v234, v234, v175
    v_add_f32 v249, v249, v184
    v_add_f32 v249, v249, v185
    v_cvt_pk_bf16_f32 v184, v184, v185
    v_exp_f32 v192, v192
    v_exp_f32 v193, v193
    v_add_f32 v249, v249, v186
    v_add_f32 v249, v249, v187
    v_exp_f32 v194, v194
    v_exp_f32 v195, v195
    v_add_u32 v254, s69, v236
    v_add_u32 v255, s69, v237
    s_waitcnt vmcnt(9)
    s_barrier
    ds_read_b128 a[48:51], v254 offset:0
    ds_read_b128 a[52:55], v255 offset:0
    ds_read_b128 a[56:59], v254 offset:128
    ds_read_b128 a[60:63], v255 offset:128
    ds_read_b128 a[64:67], v254 offset:256
    ds_read_b128 a[68:71], v255 offset:256
    s_waitcnt lgkmcnt(0)
    v_mfma_f32_16x16x32_bf16 v[228:231], a[72:75], a[48:51], 0
    v_mfma_f32_16x16x32_bf16 v[228:231], a[76:79], a[52:55], v[228:231]
    v_mfma_f32_16x16x32_bf16 v[228:231], a[80:83], a[56:59], v[228:231]
    v_mfma_f32_16x16x32_bf16 v[228:231], a[84:87], a[60:63], v[228:231]
    v_mfma_f32_16x16x32_bf16 v[228:231], a[88:91], a[64:67], v[228:231]
    v_mfma_f32_16x16x32_bf16 v[228:231], a[92:95], a[68:71], v[228:231]
    v_mfma_f32_4x4x4_16b_bf16 v[112:115], v[128:129], a[48:49], 0
    s_add_u32 m0, s40, 0
    s_nop 0
    buffer_load_dwordx4 v242, s[72:75], s36 offen offset:0 nt lds
    v_mfma_f32_4x4x4_16b_bf16 v[116:119], v[128:129], a[50:51], 0
    v_mfma_f32_4x4x4_16b_bf16 v[112:115], v[130:131], a[48:49], v[112:115]
    v_mfma_f32_4x4x4_16b_bf16 v[120:123], v[128:129], a[52:53], 0
    v_mfma_f32_4x4x4_16b_bf16 v[116:119], v[130:131], a[50:51], v[116:119]
    v_max3_f32 v176, v228, v229, v230
    v_mfma_f32_4x4x4_16b_bf16 v[124:127], v[128:129], a[54:55], 0
    s_nop 0
    v_cvt_pk_bf16_f32 v132, v112, v113
    v_mfma_f32_4x4x4_16b_bf16 v[120:123], v[130:131], a[52:53], v[120:123]
    v_cvt_pk_bf16_f32 v133, v114, v115
    v_max_f32 v176, v176, v231
    s_add_u32 m0, s40, 0
    s_nop 0
    buffer_load_dwordx4 v246, s[72:75], s36 offen offset:1024 nt lds
    v_mfma_f32_4x4x4_16b_bf16 v[112:115], v[128:129], a[56:57], 0
    v_cvt_pk_bf16_f32 v134, v116, v117
    v_mfma_f32_4x4x4_16b_bf16 v[124:127], v[130:131], a[54:55], v[124:127]
    v_cvt_pk_bf16_f32 v135, v118, v119
    v_accvgpr_write_b32 a216, v132
    v_accvgpr_write_b32 a217, v133
    v_mov_b32 v177, v176
    v_mfma_f32_4x4x4_16b_bf16 v[116:119], v[128:129], a[58:59], 0
    v_cvt_pk_bf16_f32 v132, v120, v121
    v_mfma_f32_4x4x4_16b_bf16 v[112:115], v[130:131], a[56:57], v[112:115]
    v_cvt_pk_bf16_f32 v133, v122, v123
    v_accvgpr_write_b32 a218, v134
    v_accvgpr_write_b32 a219, v135
    v_permlane32_swap_b32 v176, v177
    s_nop 1
    v_mfma_f32_4x4x4_16b_bf16 v[120:123], v[128:129], a[60:61], 0
    v_cvt_pk_bf16_f32 v134, v124, v125
    v_mfma_f32_4x4x4_16b_bf16 v[116:119], v[130:131], a[58:59], v[116:119]
    v_cvt_pk_bf16_f32 v135, v126, v127
    v_accvgpr_write_b32 a220, v132
    v_accvgpr_write_b32 a221, v133
    v_max_f32 v176, v176, v177
    v_mov_b32 v177, v176
    s_add_u32 m0, s40, 0
    s_nop 0
    buffer_load_dwordx4 v253, s[72:75], s36 offen offset:2048 nt lds
    v_mfma_f32_4x4x4_16b_bf16 v[124:127], v[128:129], a[62:63], 0
    v_cvt_pk_bf16_f32 v132, v112, v113
    v_mfma_f32_4x4x4_16b_bf16 v[120:123], v[130:131], a[60:61], v[120:123]
    v_cvt_pk_bf16_f32 v133, v114, v115
    v_accvgpr_write_b32 a222, v134
    v_accvgpr_write_b32 a223, v135
    v_permlane16_swap_b32 v176, v177
    s_nop 1
    v_mfma_f32_4x4x4_16b_bf16 v[112:115], v[128:129], a[64:65], 0
    v_cvt_pk_bf16_f32 v134, v116, v117
    v_mfma_f32_4x4x4_16b_bf16 v[124:127], v[130:131], a[62:63], v[124:127]
    v_cvt_pk_bf16_f32 v135, v118, v119
    v_accvgpr_write_b32 a224, v132
    v_accvgpr_write_b32 a225, v133
    v_max_f32 v176, v176, v177
    v_mfma_f32_4x4x4_16b_bf16 v[116:119], v[128:129], a[66:67], 0
    v_cvt_pk_bf16_f32 v132, v120, v121
    v_mfma_f32_4x4x4_16b_bf16 v[112:115], v[130:131], a[64:65], v[112:115]
    v_cvt_pk_bf16_f32 v133, v122, v123
    v_accvgpr_write_b32 a226, v134
    v_accvgpr_write_b32 a227, v135
    v_mul_f32 v228, s28, v176
    s_add_u32 m0, s40, 12288
    s_nop 0
    buffer_load_dwordx4 v242, s[72:75], s37 offen offset:0 nt lds
    v_mfma_f32_4x4x4_16b_bf16 v[120:123], v[128:129], a[68:69], 0
    v_cvt_pk_bf16_f32 v134, v124, v125
    v_mfma_f32_4x4x4_16b_bf16 v[116:119], v[130:131], a[66:67], v[116:119]
    v_cvt_pk_bf16_f32 v135, v126, v127
    v_accvgpr_write_b32 a228, v132
    v_accvgpr_write_b32 a229, v133
    v_mul_f32 v229, s28, v176
    v_mfma_f32_4x4x4_16b_bf16 v[124:127], v[128:129], a[70:71], 0
    v_cvt_pk_bf16_f32 v144, v112, v113
    v_mfma_f32_4x4x4_16b_bf16 v[120:123], v[130:131], a[68:69], v[120:123]
    v_cvt_pk_bf16_f32 v145, v114, v115
    v_accvgpr_write_b32 a230, v134
    v_accvgpr_write_b32 a231, v135
    v_mul_f32 v230, s28, v176
    v_mul_f32 v231, s28, v176
    v_cvt_pk_bf16_f32 v146, v116, v117
    v_mfma_f32_4x4x4_16b_bf16 v[124:127], v[130:131], a[70:71], v[124:127]
    v_cvt_pk_bf16_f32 v147, v118, v119
    s_add_u32 m0, s40, 12288
    s_nop 0
    buffer_load_dwordx4 v246, s[72:75], s37 offen offset:1024 nt lds
    v_cvt_pk_bf16_f32 v148, v120, v121
    v_cvt_pk_bf16_f32 v149, v122, v123
    v_cvt_pk_bf16_f32 v150, v124, v125
    v_cvt_pk_bf16_f32 v151, v126, v127
    v_mfma_f32_16x16x32_bf16 v[208:211], a[0:3], a[216:219], v[228:231]
    v_mfma_f32_16x16x32_bf16 v[212:215], a[24:27], a[216:219], v[228:231]
    v_mfma_f32_16x16x32_bf16 v[208:211], a[4:7], a[220:223], v[208:211]
    v_mfma_f32_16x16x32_bf16 v[212:215], a[28:31], a[220:223], v[212:215]
    s_add_u32 m0, s40, 12288
    s_nop 0
    buffer_load_dwordx4 v253, s[72:75], s37 offen offset:2048 nt lds
    v_mfma_f32_16x16x32_bf16 v[208:211], a[8:11], a[224:227], v[208:211]
    v_mfma_f32_16x16x32_bf16 v[212:215], a[32:35], a[224:227], v[212:215]
    v_mfma_f32_16x16x32_bf16 v[208:211], a[12:15], a[228:231], v[208:211]
    v_mfma_f32_16x16x32_bf16 v[212:215], a[36:39], a[228:231], v[212:215]
    s_add_u32 m0, s38, 0
    s_nop 0
    buffer_load_dwordx4 v242, s[84:87], s36 offen offset:0 nt lds
    v_mfma_f32_16x16x32_bf16 v[208:211], a[16:19], v[144:147], v[208:211]
    v_mfma_f32_16x16x32_bf16 v[212:215], a[40:43], v[144:147], v[212:215]
    v_mfma_f32_16x16x32_bf16 v[208:211], a[20:23], v[148:151], v[208:211]
    v_mfma_f32_16x16x32_bf16 v[212:215], a[44:47], v[148:151], v[212:215]
    s_add_u32 m0, s38, 0
    s_nop 0
    buffer_load_dwordx4 v246, s[84:87], s36 offen offset:1024 nt lds
    v_mfma_f32_32x32x16_bf16 v[112:127], v[0:3], v[0:3], 0
    v_mfma_f32_32x32x16_bf16 v[128:143], v[0:3], v[0:3], 0
    v_mfma_f32_32x32x16_bf16 a[0:15], v[0:3], v[0:3], 0
    v_mfma_f32_32x32x16_bf16 a[16:31], v[0:3], v[0:3], 0
    v_mfma_f32_32x32x16_bf16 a[32:47], v[0:3], v[0:3], 0
    s_nop 0
    s_add_u32 m0, s38, 0
    s_nop 0
    buffer_load_dwordx4 v253, s[84:87], s36 offen offset:2048 nt lds
    s_add_u32 m0, s38, 12288
    s_nop 0
    buffer_load_dwordx4 v242, s[84:87], s37 offen offset:0 nt lds
    s_add_u32 m0, s38, 12288
    s_nop 0
    buffer_load_dwordx4 v246, s[84:87], s37 offen offset:1024 nt lds
    s_add_u32 m0, s38, 12288
    s_nop 0
    buffer_load_dwordx4 v253, s[84:87], s37 offen offset:2048 nt lds
    s_waitcnt vmcnt(12)
    s_barrier
    ds_read_b64_tr_b16 a[232:233], v238 offset:24576
    ds_read_b64_tr_b16 a[234:235], v238 offset:30720
    ds_read_b64_tr_b16 a[236:237], v239 offset:24576
    ds_read_b64_tr_b16 a[238:239], v239 offset:30720
    ds_read_b64_tr_b16 a[240:241], v240 offset:24576
    ds_read_b64_tr_b16 a[242:243], v240 offset:30720
    ds_read_b64_tr_b16 a[244:245], v241 offset:24576
    ds_read_b64_tr_b16 a[246:247], v241 offset:30720
    s_add_u32 s40, s70, 98304
    s_add_u32 s38, s71, 98304
    s_add_u32 s36, s36, 24576
    s_add_u32 s37, s37, 24576
    s_mov_b32 s64, s40
    s_mov_b32 s65, s38
    s_mov_b64 vcc, -1
    s_mov_b32 s45, 2
    s_waitcnt lgkmcnt(0)
    s_call_b64 s[62:63], L_e_p2
    v_mfma_f32_16x16x32_bf16 v[140:143], a[252:255], v[200:203], v[140:143]
    v_mfma_f32_16x16x32_bf16 v[92:95], a[252:255], v[192:195], v[92:95]
    v_mfma_f32_16x16x32_bf16 v[44:47], a[252:255], v[184:187], v[44:47]
    s_call_b64 s[62:63], L_e_body
    v_mfma_f32_16x16x32_bf16 v[140:143], a[252:255], v[200:203], v[140:143]
    v_mfma_f32_16x16x32_bf16 v[92:95], a[252:255], v[192:195], v[92:95]
    v_mfma_f32_16x16x32_bf16 v[44:47], a[252:255], v[184:187], v[44:47]
    s_call_b64 s[62:63], L_e_body
    v_mfma_f32_16x16x32_bf16 v[140:143], a[252:255], v[200:203], v[140:143]
    buffer_load_dwordx4 a[48:51], v243, s[16:19], s32 offen offset:0 nt
    v_mfma_f32_16x16x32_bf16 v[92:95], a[252:255], v[192:195], v[92:95]
    buffer_load_dwordx4 a[52:55], v243, s[16:19], s32 offen offset:64 nt
    v_mfma_f32_16x16x32_bf16 v[44:47], a[252:255], v[184:187], v[44:47]
    s_call_b64 s[62:63], L_e_body
    v_mfma_f32_16x16x32_bf16 v[140:143], a[252:255], v[200:203], v[140:143]
    buffer_load_dwordx4 a[56:59], v243, s[16:19], s32 offen offset:128 nt
    v_mfma_f32_16x16x32_bf16 v[92:95], a[252:255], v[192:195], v[92:95]
    buffer_load_dwordx4 a[60:63], v243, s[16:19], s32 offen offset:192 nt
    v_mfma_f32_16x16x32_bf16 v[44:47], a[252:255], v[184:187], v[44:47]
    s_call_b64 s[62:63], L_e_body
    v_mfma_f32_16x16x32_bf16 v[140:143], a[252:255], v[200:203], v[140:143]
    buffer_load_dwordx4 a[64:67], v243, s[16:19], s32 offen offset:256 nt
    v_mfma_f32_16x16x32_bf16 v[92:95], a[252:255], v[192:195], v[92:95]
    buffer_load_dwordx4 a[68:71], v243, s[16:19], s32 offen offset:320 nt
    v_mfma_f32_16x16x32_bf16 v[44:47], a[252:255], v[184:187], v[44:47]
    s_call_b64 s[62:63], L_e_body
    v_mfma_f32_16x16x32_bf16 v[140:143], a[252:255], v[200:203], v[140:143]
    buffer_load_dwordx4 a[72:75], v243, s[16:19], s33 offen offset:0 nt
    v_mfma_f32_16x16x32_bf16 v[92:95], a[252:255], v[192:195], v[92:95]
    buffer_load_dwordx4 a[76:79], v243, s[16:19], s33 offen offset:64 nt
    v_mfma_f32_16x16x32_bf16 v[44:47], a[252:255], v[184:187], v[44:47]
    s_call_b64 s[62:63], L_e_body
    v_mfma_f32_16x16x32_bf16 v[140:143], a[252:255], v[200:203], v[140:143]
    buffer_load_dwordx4 a[80:83], v243, s[16:19], s33 offen offset:128 nt
    v_mfma_f32_16x16x32_bf16 v[92:95], a[252:255], v[192:195], v[92:95]
    buffer_load_dwordx4 a[84:87], v243, s[16:19], s33 offen offset:192 nt
    v_mfma_f32_16x16x32_bf16 v[44:47], a[252:255], v[184:187], v[44:47]
    s_call_b64 s[62:63], L_e_body
    v_mfma_f32_16x16x32_bf16 v[140:143], a[252:255], v[200:203], v[140:143]
    buffer_load_dwordx4 a[88:91], v243, s[16:19], s33 offen offset:256 nt
    v_mfma_f32_16x16x32_bf16 v[92:95], a[252:255], v[192:195], v[92:95]
    buffer_load_dwordx4 a[92:95], v243, s[16:19], s33 offen offset:320 nt
    v_mfma_f32_16x16x32_bf16 v[44:47], a[252:255], v[184:187], v[44:47]
    s_call_b64 s[62:63], L_e_body
    v_mfma_f32_16x16x32_bf16 v[140:143], a[252:255], v[200:203], v[140:143]
    buffer_load_dwordx4 a[96:99], v243, s[16:19], s34 offen offset:0 nt
    v_mfma_f32_16x16x32_bf16 v[92:95], a[252:255], v[192:195], v[92:95]
    buffer_load_dwordx4 a[100:103], v243, s[16:19], s34 offen offset:64 nt
    v_mfma_f32_16x16x32_bf16 v[44:47], a[252:255], v[184:187], v[44:47]
    s_call_b64 s[62:63], L_e_body
    v_mfma_f32_16x16x32_bf16 v[140:143], a[252:255], v[200:203], v[140:143]
    buffer_load_dwordx4 a[104:107], v243, s[16:19], s34 offen offset:128 nt
    v_mfma_f32_16x16x32_bf16 v[92:95], a[252:255], v[192:195], v[92:95]
    buffer_load_dwordx4 a[108:111], v243, s[16:19], s34 offen offset:192 nt
    v_mfma_f32_16x16x32_bf16 v[44:47], a[252:255], v[184:187], v[44:47]
    s_call_b64 s[62:63], L_e_body
    v_mfma_f32_16x16x32_bf16 v[140:143], a[252:255], v[200:203], v[140:143]
    buffer_load_dwordx4 a[112:115], v243, s[16:19], s34 offen offset:256 nt
    v_mfma_f32_16x16x32_bf16 v[92:95], a[252:255], v[192:195], v[92:95]
    buffer_load_dwordx4 a[116:119], v243, s[16:19], s34 offen offset:320 nt
    v_mfma_f32_16x16x32_bf16 v[44:47], a[252:255], v[184:187], v[44:47]
    s_call_b64 s[62:63], L_e_body
    v_mfma_f32_16x16x32_bf16 v[140:143], a[252:255], v[200:203], v[140:143]
    buffer_load_dwordx4 a[120:123], v243, s[16:19], s35 offen offset:0 nt
    v_mfma_f32_16x16x32_bf16 v[92:95], a[252:255], v[192:195], v[92:95]
    buffer_load_dwordx4 a[124:127], v243, s[16:19], s35 offen offset:64 nt
    v_mfma_f32_16x16x32_bf16 v[44:47], a[252:255], v[184:187], v[44:47]
    s_call_b64 s[62:63], L_e_body
    v_mfma_f32_16x16x32_bf16 v[140:143], a[252:255], v[200:203], v[140:143]
    buffer_load_dwordx4 a[128:131], v243, s[16:19], s35 offen offset:128 nt
    v_mfma_f32_16x16x32_bf16 v[92:95], a[252:255], v[192:195], v[92:95]
    buffer_load_dwordx4 a[132:135], v243, s[16:19], s35 offen offset:192 nt
    v_mfma_f32_16x16x32_bf16 v[44:47], a[252:255], v[184:187], v[44:47]
    s_call_b64 s[62:63], L_e_body
    v_mfma_f32_16x16x32_bf16 v[140:143], a[252:255], v[200:203], v[140:143]
    buffer_load_dwordx4 a[136:139], v243, s[16:19], s35 offen offset:256 nt
    v_mfma_f32_16x16x32_bf16 v[92:95], a[252:255], v[192:195], v[92:95]
    buffer_load_dwordx4 a[140:143], v243, s[16:19], s35 offen offset:320 nt
    v_mfma_f32_16x16x32_bf16 v[44:47], a[252:255], v[184:187], v[44:47]
    s_call_b64 s[62:63], L_e_body
    v_mfma_f32_16x16x32_bf16 v[140:143], a[252:255], v[200:203], v[140:143]
    v_mfma_f32_16x16x32_bf16 v[92:95], a[252:255], v[192:195], v[92:95]
    s_mov_b64 vcc, -1
    v_mfma_f32_16x16x32_bf16 v[44:47], a[252:255], v[184:187], v[44:47]
    s_branch L_e_body
L_e_exit2:
    s_mov_b64 vcc, 0
    s_mov_b32 s45, 0
    s_mov_b32 s66, m0
    s_add_u32 m0, s64, 0
    s_nop 0
    buffer_load_dwordx4 v242, s[72:75], s36 offen offset:0 nt lds
    s_add_u32 m0, s64, 0
    s_nop 0
    buffer_load_dwordx4 v246, s[72:75], s36 offen offset:1024 nt lds
    s_add_u32 m0, s64, 0
    s_nop 0
    buffer_load_dwordx4 v253, s[72:75], s36 offen offset:2048 nt lds
    s_add_u32 m0, s64, 12288
    s_nop 0
    buffer_load_dwordx4 v242, s[72:75], s37 offen offset:0 nt lds
    s_add_u32 m0, s64, 12288
    s_nop 0
    buffer_load_dwordx4 v246, s[72:75], s37 offen offset:1024 nt lds
    s_add_u32 m0, s64, 12288
    s_nop 0
    buffer_load_dwordx4 v253, s[72:75], s37 offen offset:2048 nt lds
    s_add_u32 m0, s65, 0
    s_nop 0
    buffer_load_dwordx4 v242, s[84:87], s36 offen offset:0 nt lds
    s_mov_b32 m0, s66
    s_branch L_e_p4
L_e_exit:
    s_cmp_eq_u32 s45, 2
    s_cbranch_scc1 L_e_mid
    s_mov_b64 vcc, 0
    s_cmp_lg_u32 s45, 0
    s_cbranch_scc1 L_e_fin
    s_call_b64 s[62:63], L_psx
    s_nop 1
    s_call_b64 s[62:63], L_e_mid
    v_mfma_f32_16x16x32_bf16 v[140:143], a[252:255], v[200:203], v[140:143]
    v_mfma_f32_16x16x32_bf16 v[92:95], a[252:255], v[192:195], v[92:95]
    v_mfma_f32_16x16x32_bf16 v[44:47], a[252:255], v[184:187], v[44:47]
    s_call_b64 s[62:63], L_pk
    s_mov_b32 s45, 1
    s_or_b32 s46, s78, s79
    s_mov_b64 s[78:79], 0
    s_call_b64 s[62:63], L_e_body
    v_mfma_f32_16x16x32_bf16 v[140:143], a[252:255], v[200:203], v[140:143]
    buffer_store_dwordx4 a[48:51], v244, s[20:23], s32 offen offset:0 sc1
    v_mfma_f32_16x16x32_bf16 v[92:95], a[252:255], v[192:195], v[92:95]
    v_mfma_f32_16x16x32_bf16 v[44:47], a[252:255], v[184:187], v[44:47]
    s_call_b64 s[62:63], L_e_body
    v_mfma_f32_16x16x32_bf16 v[140:143], a[252:255], v[200:203], v[140:143]
    buffer_store_dwordx4 a[52:55], v244, s[20:23], s32 offen offset:64 sc1
    v_mfma_f32_16x16x32_bf16 v[92:95], a[252:255], v[192:195], v[92:95]
    v_mfma_f32_16x16x32_bf16 v[44:47], a[252:255], v[184:187], v[44:47]
    s_call_b64 s[62:63], L_e_body
    v_mfma_f32_16x16x32_bf16 v[140:143], a[252:255], v[200:203], v[140:143]
    buffer_store_dwordx4 a[56:59], v244, s[20:23], s32 offen offset:128 sc1
    v_mfma_f32_16x16x32_bf16 v[92:95], a[252:255], v[192:195], v[92:95]
    v_mfma_f32_16x16x32_bf16 v[44:47], a[252:255], v[184:187], v[44:47]
    s_call_b64 s[62:63], L_e_body
    v_mfma_f32_16x16x32_bf16 v[140:143], a[252:255], v[200:203], v[140:143]
    buffer_store_dwordx4 a[60:63], v244, s[20:23], s32 offen offset:192 sc1
    v_mfma_f32_16x16x32_bf16 v[92:95], a[252:255], v[192:195], v[92:95]
    v_mfma_f32_16x16x32_bf16 v[44:47], a[252:255], v[184:187], v[44:47]
    s_call_b64 s[62:63], L_e_body
    v_mfma_f32_16x16x32_bf16 v[140:143], a[252:255], v[200:203], v[140:143]
    buffer_store_dwordx4 a[64:67], v244, s[20:23], s32 offen offset:256 sc1
    v_mfma_f32_16x16x32_bf16 v[92:95], a[252:255], v[192:195], v[92:95]
    v_mfma_f32_16x16x32_bf16 v[44:47], a[252:255], v[184:187], v[44:47]
    s_call_b64 s[62:63], L_e_body
    v_mfma_f32_16x16x32_bf16 v[140:143], a[252:255], v[200:203], v[140:143]
    buffer_store_dwordx4 a[68:71], v244, s[20:23], s32 offen offset:320 sc1
    v_mfma_f32_16x16x32_bf16 v[92:95], a[252:255], v[192:195], v[92:95]
    v_mfma_f32_16x16x32_bf16 v[44:47], a[252:255], v[184:187], v[44:47]
    s_call_b64 s[62:63], L_e_body
    v_mfma_f32_16x16x32_bf16 v[140:143], a[252:255], v[200:203], v[140:143]
    buffer_store_dwordx4 a[72:75], v244, s[20:23], s33 offen offset:0 sc1
    v_mfma_f32_16x16x32_bf16 v[92:95], a[252:255], v[192:195], v[92:95]
    v_mfma_f32_16x16x32_bf16 v[44:47], a[252:255], v[184:187], v[44:47]
    s_call_b64 s[62:63], L_e_body
    v_mfma_f32_16x16x32_bf16 v[140:143], a[252:255], v[200:203], v[140:143]
    buffer_store_dwordx4 a[80:83], v244, s[20:23], s33 offen offset:128 sc1
    v_mfma_f32_16x16x32_bf16 v[92:95], a[252:255], v[192:195], v[92:95]
    v_mfma_f32_16x16x32_bf16 v[44:47], a[252:255], v[184:187], v[44:47]
    s_call_b64 s[62:63], L_e_body
    v_mfma_f32_16x16x32_bf16 v[140:143], a[252:255], v[200:203], v[140:143]
    buffer_store_dwordx4 a[88:91], v244, s[20:23], s33 offen offset:256 sc1
    v_mfma_f32_16x16x32_bf16 v[92:95], a[252:255], v[192:195], v[92:95]
    v_mfma_f32_16x16x32_bf16 v[44:47], a[252:255], v[184:187], v[44:47]
    s_call_b64 s[62:63], L_e_body
    v_mfma_f32_16x16x32_bf16 v[140:143], a[252:255], v[200:203], v[140:143]
    buffer_store_dwordx4 a[96:99], v244, s[20:23], s34 offen offset:0 sc1
    v_mfma_f32_16x16x32_bf16 v[92:95], a[252:255], v[192:195], v[92:95]
    v_mfma_f32_16x16x32_bf16 v[44:47], a[252:255], v[184:187], v[44:47]
    s_call_b64 s[62:63], L_e_body
    v_mfma_f32_16x16x32_bf16 v[140:143], a[252:255], v[200:203], v[140:143]
    buffer_store_dwordx4 a[104:107], v244, s[20:23], s34 offen offset:128 sc1
    v_mfma_f32_16x16x32_bf16 v[92:95], a[252:255], v[192:195], v[92:95]
    v_mfma_f32_16x16x32_bf16 v[44:47], a[252:255], v[184:187], v[44:47]
    s_call_b64 s[62:63], L_e_body
    v_mfma_f32_16x16x32_bf16 v[140:143], a[252:255], v[200:203], v[140:143]
    buffer_store_dwordx4 a[112:115], v244, s[20:23], s34 offen offset:256 sc1
    v_mfma_f32_16x16x32_bf16 v[92:95], a[252:255], v[192:195], v[92:95]
    v_mfma_f32_16x16x32_bf16 v[44:47], a[252:255], v[184:187], v[44:47]
    s_call_b64 s[62:63], L_e_body
    v_mfma_f32_16x16x32_bf16 v[140:143], a[252:255], v[200:203], v[140:143]
    buffer_store_dwordx4 a[120:123], v244, s[20:23], s93 offen offset:0 sc1
    v_mfma_f32_16x16x32_bf16 v[92:95], a[252:255], v[192:195], v[92:95]
    v_mfma_f32_16x16x32_bf16 v[44:47], a[252:255], v[184:187], v[44:47]
    s_call_b64 s[62:63], L_e_body
    v_mfma_f32_16x16x32_bf16 v[140:143], a[252:255], v[200:203], v[140:143]
    buffer_store_dwordx4 a[124:127], v244, s[20:23], s93 offen offset:64 sc1
    v_mfma_f32_16x16x32_bf16 v[92:95], a[252:255], v[192:195], v[92:95]
    v_mfma_f32_16x16x32_bf16 v[44:47], a[252:255], v[184:187], v[44:47]
    s_call_b64 s[62:63], L_e_body
    v_mfma_f32_16x16x32_bf16 v[140:143], a[252:255], v[200:203], v[140:143]
    buffer_store_dwordx4 a[128:131], v244, s[20:23], s93 offen offset:128 sc1
    v_mfma_f32_16x16x32_bf16 v[92:95], a[252:255], v[192:195], v[92:95]
    s_mov_b64 vcc, -1
    v_mfma_f32_16x16x32_bf16 v[44:47], a[252:255], v[184:187], v[44:47]
    s_branch L_e_body
L_e_fin:
    s_waitcnt lgkmcnt(0)
    ds_read_b64_tr_b16 a[144:145], v238 offset:36864
    ds_read_b64_tr_b16 a[146:147], v238 offset:43008
    ds_read_b64_tr_b16 a[148:149], v239 offset:36864
    ds_read_b64_tr_b16 a[150:151], v239 offset:43008
    ds_read_b64_tr_b16 a[152:153], v240 offset:36864
    ds_read_b64_tr_b16 a[154:155], v240 offset:43008
    ds_read_b64_tr_b16 a[156:157], v241 offset:36864
    ds_read_b64_tr_b16 a[158:159], v241 offset:43008
    v_cvt_pk_bf16_f32 v187, v190, v191
    v_add_f32 v249, v249, v188
    ds_read_b64_tr_b16 a[160:161], v238 offset:36992
    v_add_f32 v249, v249, v189
    v_add_f32 v249, v249, v190
    ds_read_b64_tr_b16 a[162:163], v238 offset:43136
    v_add_f32 v249, v249, v191
    v_add_f32 v249, v249, v232
    ds_read_b64_tr_b16 a[164:165], v239 offset:36992
    v_lshrrev_b32 v173, 4, v245
    v_and_b32 v176, 15, v173
    ds_read_b64_tr_b16 a[166:167], v239 offset:43136
    v_mul_u32_u24 v176, 400, v176
    v_lshrrev_b32 v174, 4, v173
    ds_read_b64_tr_b16 a[168:169], v240 offset:36992
    v_lshl_add_u32 v176, v174, 3, v176
    v_add_u32 v176, s99, v176
    ds_read_b64_tr_b16 a[170:171], v240 offset:43136
    s_waitcnt vmcnt(0)
    s_barrier
    s_waitcnt lgkmcnt(12)
    v_mfma_f32_16x16x32_bf16 v[0:3], a[144:147], v[184:187], v[0:3]
    ds_read_b64_tr_b16 a[172:173], v241 offset:36992
    ds_read_b64_tr_b16 a[174:175], v241 offset:43136
    v_mov_b32 v172, v249
    v_exp_f32 v199, v199
    s_nop 0
    v_permlane32_swap_b32 v249, v172
    s_waitcnt lgkmcnt(12)
    s_nop 0
    v_mfma_f32_16x16x32_bf16 v[4:7], a[148:151], v[184:187], v[4:7]
    ds_read_b64_tr_b16 a[176:177], v238 offset:37120
    ds_read_b64_tr_b16 a[178:179], v238 offset:43264
    v_cvt_pk_bf16_f32 v194, v196, v197
    v_add_f32 v249, v249, v172
    v_cvt_pk_bf16_f32 v195, v198, v199
    s_waitcnt lgkmcnt(12)
    v_mfma_f32_16x16x32_bf16 v[8:11], a[152:155], v[184:187], v[8:11]
    ds_read_b64_tr_b16 a[180:181], v239 offset:37120
    ds_read_b64_tr_b16 a[182:183], v239 offset:43264
    v_mov_b32 v172, v249
    v_add_f32 v250, v250, v196
    s_nop 0
    v_permlane16_swap_b32 v249, v172
    s_waitcnt lgkmcnt(12)
    s_nop 0
    v_mfma_f32_16x16x32_bf16 v[12:15], a[156:159], v[184:187], v[12:15]
    ds_read_b64_tr_b16 a[184:185], v240 offset:37120
    ds_read_b64_tr_b16 a[186:187], v240 offset:43264
    v_add_f32 v250, v250, v197
    v_add_f32 v249, v249, v172
    v_add_f32 v250, v250, v198
    s_waitcnt lgkmcnt(12)
    v_mfma_f32_16x16x32_bf16 v[16:19], a[160:163], v[184:187], v[16:19]
    ds_read_b64_tr_b16 a[188:189], v241 offset:37120
    ds_read_b64_tr_b16 a[190:191], v241 offset:43264
    v_rcp_f32 v168, v249
    v_add_f32 v250, v250, v199
    v_cmp_nle_f32 s[60:61], v249, s48
    s_waitcnt lgkmcnt(12)
    v_mfma_f32_16x16x32_bf16 v[20:23], a[164:167], v[184:187], v[20:23]
    v_exp_f32 v212, v212
    v_cmp_nge_f32 s[80:81], v249, s29
    v_exp_f32 v213, v213
    s_or_b64 s[78:79], s[78:79], s[60:61]
    s_waitcnt lgkmcnt(10)
    v_mfma_f32_16x16x32_bf16 v[24:27], a[168:171], v[184:187], v[24:27]
    v_exp_f32 v214, v214
    s_or_b64 s[78:79], s[78:79], s[80:81]
    v_exp_f32 v215, v215
    s_waitcnt lgkmcnt(8)
    v_mfma_f32_16x16x32_bf16 v[28:31], a[172:175], v[184:187], v[28:31]
    v_cvt_pk_bf16_f32 v210, v212, v213
    v_cvt_pk_bf16_f32 v211, v214, v215
    v_add_f32 v252, v252, v212
    s_waitcnt lgkmcnt(6)
    v_mfma_f32_16x16x32_bf16 v[32:35], a[176:179], v[184:187], v[32:35]
    v_add_f32 v252, v252, v213
    v_add_f32 v252, v252, v214
    v_add_f32 v252, v252, v215
    s_waitcnt lgkmcnt(4)
    v_mfma_f32_16x16x32_bf16 v[36:39], a[180:183], v[184:187], v[36:39]
    v_exp_f32 v204, v204
    v_exp_f32 v205, v205
    v_exp_f32 v206, v206
    s_waitcnt lgkmcnt(2)
    v_mfma_f32_16x16x32_bf16 v[40:43], a[184:187], v[184:187], v[40:43]
    v_exp_f32 v207, v207
    v_cvt_pk_bf16_f32 v202, v204, v205
    v_cvt_pk_bf16_f32 v203, v206, v207
    s_waitcnt lgkmcnt(0)
    v_mfma_f32_16x16x32_bf16 v[44:47], a[188:191], v[184:187], v[44:47]
    v_add_f32 v251, v251, v204
    v_add_f32 v251, v251, v205
    v_add_f32 v251, v251, v206
    v_add_f32 v251, v251, v207
    s_nop 3
    s_branch L_fin
L_o_start:
    v_exp_f32 v184, v184
    v_add_f32 v232, v232, v156
    v_add_f32 v232, v232, v157
    v_exp_f32 v185, v185
    v_add_f32 v232, v232, v158
    v_add_f32 v232, v232, v159
    v_exp_f32 v186, v186
    v_add_f32 v233, v233, v164
    v_add_f32 v233, v233, v165
    v_exp_f32 v187, v187
    v_mfma_f32_32x32x16_bf16 a[0:15], v[0:3], v[0:3], 0
    v_mfma_f32_32x32x16_bf16 a[16:31], v[0:3], v[0:3], 0
    v_mfma_f32_32x32x16_bf16 a[32:47], v[0:3], v[0:3], 0
    v_add_u32 v254, s69, v236
    v_add_u32 v255, s69, v237
    s_waitcnt vmcnt(9)
    s_barrier
    ds_read_b128 a[48:51], v254 offset:0
    ds_read_b128 a[52:55], v255 offset:0
    ds_read_b128 a[56:59], v254 offset:128
    ds_read_b128 a[60:63], v255 offset:128
    ds_read_b128 a[64:67], v254 offset:256
    ds_read_b128 a[68:71], v255 offset:256
    s_waitcnt lgkmcnt(0)
    v_mfma_f32_16x16x32_bf16 v[228:231], a[72:75], a[48:51], 0
    v_mfma_f32_16x16x32_bf16 v[228:231], a[76:79], a[52:55], v[228:231]
    v_mfma_f32_16x16x32_bf16 v[228:231], a[80:83], a[56:59], v[228:231]
    v_mfma_f32_16x16x32_bf16 v[228:231], a[84:87], a[60:63], v[228:231]
    v_mfma_f32_16x16x32_bf16 v[228:231], a[88:91], a[64:67], v[228:231]
    v_mfma_f32_16x16x32_bf16 v[228:231], a[92:95], a[68:71], v[228:231]
    v_mfma_f32_4x4x4_16b_bf16 v[112:115], v[128:129], a[48:49], 0
    s_add_u32 m0, s40, 0
    s_nop 0
    buffer_load_dwordx4 v242, s[72:75], s36 offen offset:0 nt lds
    v_mfma_f32_4x4x4_16b_bf16 v[116:119], v[128:129], a[50:51], 0
    v_mfma_f32_4x4x4_16b_bf16 v[112:115], v[130:131], a[48:49], v[112:115]
    v_mfma_f32_4x4x4_16b_bf16 v[120:123], v[128:129], a[52:53], 0
    v_mfma_f32_4x4x4_16b_bf16 v[116:119], v[130:131], a[50:51], v[116:119]
    v_max3_f32 v176, v228, v229, v230
    v_mfma_f32_4x4x4_16b_bf16 v[124:127], v[128:129], a[54:55], 0
    s_nop 0
    v_cvt_pk_bf16_f32 v132, v112, v113
    v_mfma_f32_4x4x4_16b_bf16 v[120:123], v[130:131], a[52:53], v[120:123]
    v_cvt_pk_bf16_f32 v133, v114, v115
    v_max_f32 v176, v176, v231
    s_add_u32 m0, s40, 0
    s_nop 0
    buffer_load_dwordx4 v246, s[72:75], s36 offen offset:1024 nt lds
    v_mfma_f32_4x4x4_16b_bf16 v[112:115], v[128:129], a[56:57], 0
    v_cvt_pk_bf16_f32 v134, v116, v117
    v_mfma_f32_4x4x4_16b_bf16 v[124:127], v[130:131], a[54:55], v[124:127]
    v_cvt_pk_bf16_f32 v135, v118, v119
    v_accvgpr_write_b32 a216, v132
    v_accvgpr_write_b32 a217, v133
    v_mov_b32 v177, v176
    v_mfma_f32_4x4x4_16b_bf16 v[116:119], v[128:129], a[58:59], 0
    v_cvt_pk_bf16_f32 v132, v120, v121
    v_mfma_f32_4x4x4_16b_bf16 v[112:115], v[130:131], a[56:57], v[112:115]
    v_cvt_pk_bf16_f32 v133, v122, v123
    v_accvgpr_write_b32 a218, v134
    v_accvgpr_write_b32 a219, v135
    v_permlane32_swap_b32 v176, v177
    s_nop 1
    v_mfma_f32_4x4x4_16b_bf16 v[120:123], v[128:129], a[60:61], 0
    v_cvt_pk_bf16_f32 v134, v124, v125
    v_mfma_f32_4x4x4_16b_bf16 v[116:119], v[130:131], a[58:59], v[116:119]
    v_cvt_pk_bf16_f32 v135, v126, v127
    v_accvgpr_write_b32 a220, v132
    v_accvgpr_write_b32 a221, v133
    v_max_f32 v176, v176, v177
    v_mov_b32 v177, v176
    s_add_u32 m0, s40, 0
    s_nop 0
    buffer_load_dwordx4 v253, s[72:75], s36 offen offset:2048 nt lds
    v_mfma_f32_4x4x4_16b_bf16 v[124:127], v[128:129], a[62:63], 0
    v_cvt_pk_bf16_f32 v132, v112, v113
    v_mfma_f32_4x4x4_16b_bf16 v[120:123], v[130:131], a[60:61], v[120:123]
    v_cvt_pk_bf16_f32 v133, v114, v115
    v_accvgpr_write_b32 a222, v134
    v_accvgpr_write_b32 a223, v135
    v_permlane16_swap_b32 v176, v177
    s_nop 1
    v_mfma_f32_4x4x4_16b_bf16 v[112:115], v[128:129], a[64:65], 0
    v_cvt_pk_bf16_f32 v134, v116, v117
    v_mfma_f32_4x4x4_16b_bf16 v[124:127], v[130:131], a[62:63], v[124:127]
    v_cvt_pk_bf16_f32 v135, v118, v119
    v_accvgpr_write_b32 a224, v132
    v_accvgpr_write_b32 a225, v133
    v_max_f32 v176, v176, v177
    v_mfma_f32_4x4x4_16b_bf16 v[116:119], v[128:129], a[66:67], 0
    v_cvt_pk_bf16_f32 v132, v120, v121
    v_mfma_f32_4x4x4_16b_bf16 v[112:115], v[130:131], a[64:65], v[112:115]
    v_cvt_pk_bf16_f32 v133, v122, v123
    v_accvgpr_write_b32 a226, v134
    v_accvgpr_write_b32 a227, v135
    v_mul_f32 v228, s28, v176
    s_add_u32 m0, s40, 12288
    s_nop 0
    buffer_load_dwordx4 v242, s[72:75], s37 offen offset:0 nt lds
    v_mfma_f32_4x4x4_16b_bf16 v[120:123], v[128:129], a[68:69], 0
    v_cvt_pk_bf16_f32 v134, v124, v125
    v_mfma_f32_4x4x4_16b_bf16 v[116:119], v[130:131], a[66:67], v[116:119]
    v_cvt_pk_bf16_f32 v135, v126, v127
    v_accvgpr_write_b32 a228, v132
    v_accvgpr_write_b32 a229, v133
    v_mul_f32 v229, s28, v176
    v_mfma_f32_4x4x4_16b_bf16 v[124:127], v[128:129], a[70:71], 0
    v_cvt_pk_bf16_f32 v144, v112, v113
    v_mfma_f32_4x4x4_16b_bf16 v[120:123], v[130:131], a[68:69], v[120:123]
    v_cvt_pk_bf16_f32 v145, v114, v115
    v_accvgpr_write_b32 a230, v134
    v_accvgpr_write_b32 a231, v135
    v_mul_f32 v230, s28, v176
    v_mul_f32 v231, s28, v176
    v_cvt_pk_bf16_f32 v146, v116, v117
    v_mfma_f32_4x4x4_16b_bf16 v[124:127], v[130:131], a[70:71], v[124:127]
    v_cvt_pk_bf16_f32 v147, v118, v119
    s_add_u32 m0, s40, 12288
    s_nop 0
    buffer_load_dwordx4 v246, s[72:75], s37 offen offset:1024 nt lds
    v_cvt_pk_bf16_f32 v148, v120, v121
    v_cvt_pk_bf16_f32 v149, v122, v123
    v_cvt_pk_bf16_f32 v150, v124, v125
    v_cvt_pk_bf16_f32 v151, v126, v127
    v_mfma_f32_16x16x32_bf16 v[176:179], a[72:75], a[216:219], v[228:231]
    v_mfma_f32_16x16x32_bf16 v[180:183], a[96:99], a[216:219], v[228:231]
    v_mfma_f32_16x16x32_bf16 v[176:179], a[76:79], a[220:223], v[176:179]
    v_mfma_f32_16x16x32_bf16 v[180:183], a[100:103], a[220:223], v[180:183]
    s_add_u32 m0, s40, 12288
    s_nop 0
    buffer_load_dwordx4 v253, s[72:75], s37 offen offset:2048 nt lds
    v_mfma_f32_16x16x32_bf16 v[176:179], a[80:83], a[224:227], v[176:179]
    v_mfma_f32_16x16x32_bf16 v[180:183], a[104:107], a[224:227], v[180:183]
    v_mfma_f32_16x16x32_bf16 v[176:179], a[84:87], a[228:231], v[176:179]
    v_mfma_f32_16x16x32_bf16 v[180:183], a[108:111], a[228:231], v[180:183]
    s_add_u32 m0, s38, 0
    s_nop 0
    buffer_load_dwordx4 v242, s[84:87], s36 offen offset:0 nt lds
    v_mfma_f32_16x16x32_bf16 v[176:179], a[88:91], v[144:147], v[176:179]
    v_mfma_f32_16x16x32_bf16 v[180:183], a[112:115], v[144:147], v[180:183]
    v_mfma_f32_16x16x32_bf16 v[176:179], a[92:95], v[148:151], v[176:179]
    v_mfma_f32_16x16x32_bf16 v[180:183], a[116:119], v[148:151], v[180:183]
    s_add_u32 m0, s38, 0
    s_nop 0
    buffer_load_dwordx4 v246, s[84:87], s36 offen offset:1024 nt lds
    v_mfma_f32_32x32x16_bf16 v[112:127], v[0:3], v[0:3], 0
    v_mfma_f32_32x32x16_bf16 v[128:143], v[0:3], v[0:3], 0
    s_nop 1
    v_exp_f32 v176, v176
    v_exp_f32 v177, v177
    v_exp_f32 v178, v178
    v_exp_f32 v179, v179
    s_add_u32 m0, s38, 0
    s_nop 0
    buffer_load_dwordx4 v253, s[84:87], s36 offen offset:2048 nt lds
    v_exp_f32 v180, v180
    v_exp_f32 v181, v181
    v_exp_f32 v182, v182
    v_exp_f32 v183, v183
    s_add_u32 m0, s38, 12288
    s_nop 0
    buffer_load_dwordx4 v242, s[84:87], s37 offen offset:0 nt lds
    v_add_f32 v235, v235, v176
    v_add_f32 v235, v235, v177
    v_cvt_pk_bf16_f32 v176, v176, v177
    v_add_f32 v235, v235, v178
    s_add_u32 m0, s38, 12288
    s_nop 0
    buffer_load_dwordx4 v246, s[84:87], s37 offen offset:1024 nt lds
    v_add_f32 v235, v235, v179
    v_cvt_pk_bf16_f32 v177, v178, v179
    v_cvt_pk_bf16_f32 v178, v180, v181
    v_cvt_pk_bf16_f32 v179, v182, v183
    s_add_u32 m0, s38, 12288
    s_nop 0
    buffer_load_dwordx4 v253, s[84:87], s37 offen offset:2048 nt lds
    s_waitcnt vmcnt(12)
    s_barrier
    ds_read_b64_tr_b16 a[232:233], v238 offset:24576
    ds_read_b64_tr_b16 a[234:235], v238 offset:30720
    ds_read_b64_tr_b16 a[236:237], v239 offset:24576
    ds_read_b64_tr_b16 a[238:239], v239 offset:30720
    ds_read_b64_tr_b16 a[240:241], v240 offset:24576
    ds_read_b64_tr_b16 a[242:243], v240 offset:30720
    ds_read_b64_tr_b16 a[244:245], v241 offset:24576
    ds_read_b64_tr_b16 a[246:247], v241 offset:30720
    s_add_u32 s40, s70, 98304
    s_add_u32 s38, s71, 98304
    s_add_u32 s36, s36, 24576
    s_add_u32 s37, s37, 24576
    s_waitcnt lgkmcnt(0)
    s_call_b64 s[62:63], L_o_p2
    v_mfma_f32_16x16x32_bf16 v[140:143], a[252:255], v[200:203], v[140:143]
    v_mfma_f32_16x16x32_bf16 v[92:95], a[252:255], v[192:195], v[92:95]
    v_mfma_f32_16x16x32_bf16 v[44:47], a[252:255], v[184:187], v[44:47]
    s_call_b64 s[62:63], L_o_body
    v_mfma_f32_16x16x32_bf16 v[140:143], a[252:255], v[200:203], v[140:143]
    v_mfma_f32_16x16x32_bf16 v[92:95], a[252:255], v[192:195], v[92:95]
    v_mfma_f32_16x16x32_bf16 v[44:47], a[252:255], v[184:187], v[44:47]
    s_call_b64 s[62:63], L_o_body
    v_mfma_f32_16x16x32_bf16 v[140:143], a[252:255], v[200:203], v[140:143]
    buffer_load_dwordx4 a[48:51], v243, s[16:19], s32 offen offset:0 nt
    v_mfma_f32_16x16x32_bf16 v[92:95], a[252:255], v[192:195], v[92:95]
    buffer_load_dwordx4 a[52:55], v243, s[16:19], s32 offen offset:64 nt
    v_mfma_f32_16x16x32_bf16 v[44:47], a[252:255], v[184:187], v[44:47]
    s_call_b64 s[62:63], L_o_body
    v_mfma_f32_16x16x32_bf16 v[140:143], a[252:255], v[200:203], v[140:143]
    buffer_load_dwordx4 a[56:59], v243, s[16:19], s32 offen offset:128 nt
    v_mfma_f32_16x16x32_bf16 v[92:95], a[252:255], v[192:195], v[92:95]
    buffer_load_dwordx4 a[60:63], v243, s[16:19], s32 offen offset:192 nt
    v_mfma_f32_16x16x32_bf16 v[44:47], a[252:255], v[184:187], v[44:47]
    s_call_b64 s[62:63], L_o_body
    v_mfma_f32_16x16x32_bf16 v[140:143], a[252:255], v[200:203], v[140:143]
    buffer_load_dwordx4 a[64:67], v243, s[16:19], s32 offen offset:256 nt
    v_mfma_f32_16x16x32_bf16 v[92:95], a[252:255], v[192:195], v[92:95]
    buffer_load_dwordx4 a[68:71], v243, s[16:19], s32 offen offset:320 nt
    v_mfma_f32_16x16x32_bf16 v[44:47], a[252:255], v[184:187], v[44:47]
    s_call_b64 s[62:63], L_o_body
    v_mfma_f32_16x16x32_bf16 v[140:143], a[252:255], v[200:203], v[140:143]
    buffer_load_dwordx4 a[72:75], v243, s[16:19], s33 offen offset:0 nt
    v_mfma_f32_16x16x32_bf16 v[92:95], a[252:255], v[192:195], v[92:95]
    buffer_load_dwordx4 a[76:79], v243, s[16:19], s33 offen offset:64 nt
    v_mfma_f32_16x16x32_bf16 v[44:47], a[252:255], v[184:187], v[44:47]
    s_call_b64 s[62:63], L_o_body
    v_mfma_f32_16x16x32_bf16 v[140:143], a[252:255], v[200:203], v[140:143]
    buffer_load_dwordx4 a[80:83], v243, s[16:19], s33 offen offset:128 nt
    v_mfma_f32_16x16x32_bf16 v[92:95], a[252:255], v[192:195], v[92:95]
    buffer_load_dwordx4 a[84:87], v243, s[16:19], s33 offen offset:192 nt
    v_mfma_f32_16x16x32_bf16 v[44:47], a[252:255], v[184:187], v[44:47]
    s_call_b64 s[62:63], L_o_body
    v_mfma_f32_16x16x32_bf16 v[140:143], a[252:255], v[200:203], v[140:143]
    buffer_load_dwordx4 a[88:91], v243, s[16:19], s33 offen offset:256 nt
    v_mfma_f32_16x16x32_bf16 v[92:95], a[252:255], v[192:195], v[92:95]
    buffer_load_dwordx4 a[92:95], v243, s[16:19], s33 offen offset:320 nt
    v_mfma_f32_16x16x32_bf16 v[44:47], a[252:255], v[184:187], v[44:47]
    s_call_b64 s[62:63], L_o_body
    v_mfma_f32_16x16x32_bf16 v[140:143], a[252:255], v[200:203], v[140:143]
    buffer_load_dwordx4 a[96:99], v243, s[16:19], s34 offen offset:0 nt
    v_mfma_f32_16x16x32_bf16 v[92:95], a[252:255], v[192:195], v[92:95]
    buffer_load_dwordx4 a[100:103], v243, s[16:19], s34 offen offset:64 nt
    v_mfma_f32_16x16x32_bf16 v[44:47], a[252:255], v[184:187], v[44:47]
    s_call_b64 s[62:63], L_o_body
    v_mfma_f32_16x16x32_bf16 v[140:143], a[252:255], v[200:203], v[140:143]
    buffer_load_dwordx4 a[104:107], v243, s[16:19], s34 offen offset:128 nt
    v_mfma_f32_16x16x32_bf16 v[92:95], a[252:255], v[192:195], v[92:95]
    buffer_load_dwordx4 a[108:111], v243, s[16:19], s34 offen offset:192 nt
    v_mfma_f32_16x16x32_bf16 v[44:47], a[252:255], v[184:187], v[44:47]
    s_call_b64 s[62:63], L_o_body
    v_mfma_f32_16x16x32_bf16 v[140:143], a[252:255], v[200:203], v[140:143]
    buffer_load_dwordx4 a[112:115], v243, s[16:19], s34 offen offset:256 nt
    v_mfma_f32_16x16x32_bf16 v[92:95], a[252:255], v[192:195], v[92:95]
    buffer_load_dwordx4 a[116:119], v243, s[16:19], s34 offen offset:320 nt
    v_mfma_f32_16x16x32_bf16 v[44:47], a[252:255], v[184:187], v[44:47]
    s_call_b64 s[62:63], L_o_body
    v_mfma_f32_16x16x32_bf16 v[140:143], a[252:255], v[200:203], v[140:143]
    buffer_load_dwordx4 a[120:123], v243, s[16:19], s35 offen offset:0 nt
    v_mfma_f32_16x16x32_bf16 v[92:95], a[252:255], v[192:195], v[92:95]
    buffer_load_dwordx4 a[124:127], v243, s[16:19], s35 offen offset:64 nt
    v_mfma_f32_16x16x32_bf16 v[44:47], a[252:255], v[184:187], v[44:47]
    s_call_b64 s[62:63], L_o_body
    v_mfma_f32_16x16x32_bf16 v[140:143], a[252:255], v[200:203], v[140:143]
    buffer_load_dwordx4 a[128:131], v243, s[16:19], s35 offen offset:128 nt
    v_mfma_f32_16x16x32_bf16 v[92:95], a[252:255], v[192:195], v[92:95]
    buffer_load_dwordx4 a[132:135], v243, s[16:19], s35 offen offset:192 nt
    v_mfma_f32_16x16x32_bf16 v[44:47], a[252:255], v[184:187], v[44:47]
    s_call_b64 s[62:63], L_o_body
    v_mfma_f32_16x16x32_bf16 v[140:143], a[252:255], v[200:203], v[140:143]
    buffer_load_dwordx4 a[136:139], v243, s[16:19], s35 offen offset:256 nt
    v_mfma_f32_16x16x32_bf16 v[92:95], a[252:255], v[192:195], v[92:95]
    buffer_load_dwordx4 a[140:143], v243, s[16:19], s35 offen offset:320 nt
    v_mfma_f32_16x16x32_bf16 v[44:47], a[252:255], v[184:187], v[44:47]
    s_call_b64 s[62:63], L_o_body
    v_mfma_f32_16x16x32_bf16 v[140:143], a[252:255], v[200:203], v[140:143]
    v_mfma_f32_16x16x32_bf16 v[92:95], a[252:255], v[192:195], v[92:95]
    s_mov_b64 vcc, -1
    v_mfma_f32_16x16x32_bf16 v[44:47], a[252:255], v[184:187], v[44:47]
    s_branch L_o_body
L_o_exit:
    s_mov_b64 vcc, 0
    s_cmp_lg_u32 s45, 0
    s_cbranch_scc1 L_o_fin
    s_call_b64 s[62:63], L_psx
    s_nop 1
    s_call_b64 s[62:63], L_o_mid
    v_mfma_f32_16x16x32_bf16 v[140:143], a[252:255], v[200:203], v[140:143]
    v_mfma_f32_16x16x32_bf16 v[92:95], a[252:255], v[192:195], v[92:95]
    v_mfma_f32_16x16x32_bf16 v[44:47], a[252:255], v[184:187], v[44:47]
    s_call_b64 s[62:63], L_pk
    s_mov_b32 s45, 1
    s_or_b32 s46, s78, s79
    s_mov_b64 s[78:79], 0
    s_call_b64 s[62:63], L_o_body
    v_mfma_f32_16x16x32_bf16 v[140:143], a[252:255], v[200:203], v[140:143]
    buffer_store_dwordx4 a[48:51], v244, s[20:23], s32 offen offset:0 sc1
    v_mfma_f32_16x16x32_bf16 v[92:95], a[252:255], v[192:195], v[92:95]
    v_mfma_f32_16x16x32_bf16 v[44:47], a[252:255], v[184:187], v[44:47]
    s_call_b64 s[62:63], L_o_body
    v_mfma_f32_16x16x32_bf16 v[140:143], a[252:255], v[200:203], v[140:143]
    buffer_store_dwordx4 a[52:55], v244, s[20:23], s32 offen offset:64 sc1
    v_mfma_f32_16x16x32_bf16 v[92:95], a[252:255], v[192:195], v[92:95]
    v_mfma_f32_16x16x32_bf16 v[44:47], a[252:255], v[184:187], v[44:47]
    s_call_b64 s[62:63], L_o_body
    v_mfma_f32_16x16x32_bf16 v[140:143], a[252:255], v[200:203], v[140:143]
    buffer_store_dwordx4 a[56:59], v244, s[20:23], s32 offen offset:128 sc1
    v_mfma_f32_16x16x32_bf16 v[92:95], a[252:255], v[192:195], v[92:95]
    v_mfma_f32_16x16x32_bf16 v[44:47], a[252:255], v[184:187], v[44:47]
    s_call_b64 s[62:63], L_o_body
    v_mfma_f32_16x16x32_bf16 v[140:143], a[252:255], v[200:203], v[140:143]
    buffer_store_dwordx4 a[60:63], v244, s[20:23], s32 offen offset:192 sc1
    v_mfma_f32_16x16x32_bf16 v[92:95], a[252:255], v[192:195], v[92:95]
    v_mfma_f32_16x16x32_bf16 v[44:47], a[252:255], v[184:187], v[44:47]
    s_call_b64 s[62:63], L_o_body
    v_mfma_f32_16x16x32_bf16 v[140:143], a[252:255], v[200:203], v[140:143]
    buffer_store_dwordx4 a[64:67], v244, s[20:23], s32 offen offset:256 sc1
    v_mfma_f32_16x16x32_bf16 v[92:95], a[252:255], v[192:195], v[92:95]
    v_mfma_f32_16x16x32_bf16 v[44:47], a[252:255], v[184:187], v[44:47]
    s_call_b64 s[62:63], L_o_body
    v_mfma_f32_16x16x32_bf16 v[140:143], a[252:255], v[200:203], v[140:143]
    buffer_store_dwordx4 a[68:71], v244, s[20:23], s32 offen offset:320 sc1
    v_mfma_f32_16x16x32_bf16 v[92:95], a[252:255], v[192:195], v[92:95]
    v_mfma_f32_16x16x32_bf16 v[44:47], a[252:255], v[184:187], v[44:47]
    s_call_b64 s[62:63], L_o_body
    v_mfma_f32_16x16x32_bf16 v[140:143], a[252:255], v[200:203], v[140:143]
    buffer_store_dwordx4 a[72:75], v244, s[20:23], s33 offen offset:0 sc1
    v_mfma_f32_16x16x32_bf16 v[92:95], a[252:255], v[192:195], v[92:95]
    v_mfma_f32_16x16x32_bf16 v[44:47], a[252:255], v[184:187], v[44:47]
    s_call_b64 s[62:63], L_o_body
    v_mfma_f32_16x16x32_bf16 v[140:143], a[252:255], v[200:203], v[140:143]
    buffer_store_dwordx4 a[80:83], v244, s[20:23], s33 offen offset:128 sc1
    v_mfma_f32_16x16x32_bf16 v[92:95], a[252:255], v[192:195], v[92:95]
    v_mfma_f32_16x16x32_bf16 v[44:47], a[252:255], v[184:187], v[44:47]
    s_call_b64 s[62:63], L_o_body
    v_mfma_f32_16x16x32_bf16 v[140:143], a[252:255], v[200:203], v[140:143]
    buffer_store_dwordx4 a[88:91], v244, s[20:23], s33 offen offset:256 sc1
    v_mfma_f32_16x16x32_bf16 v[92:95], a[252:255], v[192:195], v[92:95]
    v_mfma_f32_16x16x32_bf16 v[44:47], a[252:255], v[184:187], v[44:47]
    s_call_b64 s[62:63], L_o_body
    v_mfma_f32_16x16x32_bf16 v[140:143], a[252:255], v[200:203], v[140:143]
    buffer_store_dwordx4 a[96:99], v244, s[20:23], s34 offen offset:0 sc1
    v_mfma_f32_16x16x32_bf16 v[92:95], a[252:255], v[192:195], v[92:95]
    v_mfma_f32_16x16x32_bf16 v[44:47], a[252:255], v[184:187], v[44:47]
    s_call_b64 s[62:63], L_o_body
    v_mfma_f32_16x16x32_bf16 v[140:143], a[252:255], v[200:203], v[140:143]
    buffer_store_dwordx4 a[104:107], v244, s[20:23], s34 offen offset:128 sc1
    v_mfma_f32_16x16x32_bf16 v[92:95], a[252:255], v[192:195], v[92:95]
    v_mfma_f32_16x16x32_bf16 v[44:47], a[252:255], v[184:187], v[44:47]
    s_call_b64 s[62:63], L_o_body
    v_mfma_f32_16x16x32_bf16 v[140:143], a[252:255], v[200:203], v[140:143]
    buffer_store_dwordx4 a[112:115], v244, s[20:23], s34 offen offset:256 sc1
    v_mfma_f32_16x16x32_bf16 v[92:95], a[252:255], v[192:195], v[92:95]
    v_mfma_f32_16x16x32_bf16 v[44:47], a[252:255], v[184:187], v[44:47]
    s_call_b64 s[62:63], L_o_body
    v_mfma_f32_16x16x32_bf16 v[140:143], a[252:255], v[200:203], v[140:143]
    buffer_store_dwordx4 a[120:123], v244, s[20:23], s93 offen offset:0 sc1
    v_mfma_f32_16x16x32_bf16 v[92:95], a[252:255], v[192:195], v[92:95]
    v_mfma_f32_16x16x32_bf16 v[44:47], a[252:255], v[184:187], v[44:47]
    s_call_b64 s[62:63], L_o_body
    v_mfma_f32_16x16x32_bf16 v[140:143], a[252:255], v[200:203], v[140:143]
    buffer_store_dwordx4 a[124:127], v244, s[20:23], s93 offen offset:64 sc1
    v_mfma_f32_16x16x32_bf16 v[92:95], a[252:255], v[192:195], v[92:95]
    v_mfma_f32_16x16x32_bf16 v[44:47], a[252:255], v[184:187], v[44:47]
    s_call_b64 s[62:63], L_o_body
    v_mfma_f32_16x16x32_bf16 v[140:143], a[252:255], v[200:203], v[140:143]
    buffer_store_dwordx4 a[128:131], v244, s[20:23], s93 offen offset:128 sc1
    v_mfma_f32_16x16x32_bf16 v[92:95], a[252:255], v[192:195], v[92:95]
    s_mov_b64 vcc, -1
    v_mfma_f32_16x16x32_bf16 v[44:47], a[252:255], v[184:187], v[44:47]
    s_branch L_o_body
L_o_fin:
    s_waitcnt lgkmcnt(0)
    ds_read_b64_tr_b16 a[144:145], v238 offset:36864
    ds_read_b64_tr_b16 a[146:147], v238 offset:43008
    ds_read_b64_tr_b16 a[148:149], v239 offset:36864
    ds_read_b64_tr_b16 a[150:151], v239 offset:43008
    ds_read_b64_tr_b16 a[152:153], v240 offset:36864
    ds_read_b64_tr_b16 a[154:155], v240 offset:43008
    ds_read_b64_tr_b16 a[156:157], v241 offset:36864
    ds_read_b64_tr_b16 a[158:159], v241 offset:43008
    v_cvt_pk_bf16_f32 v186, v188, v189
    v_cvt_pk_bf16_f32 v187, v190, v191
    v_add_f32 v249, v249, v188
    ds_read_b64_tr_b16 a[160:161], v238 offset:36992
    v_add_f32 v249, v249, v189
    v_add_f32 v249, v249, v190
    ds_read_b64_tr_b16 a[162:163], v238 offset:43136
    v_add_f32 v249, v249, v191
    v_add_f32 v249, v249, v232
    ds_read_b64_tr_b16 a[164:165], v239 offset:36992
    v_lshrrev_b32 v173, 4, v245
    v_and_b32 v176, 15, v173
    ds_read_b64_tr_b16 a[166:167], v239 offset:43136
    v_mul_u32_u24 v176, 400, v176
    v_lshrrev_b32 v174, 4, v173
    ds_read_b64_tr_b16 a[168:169], v240 offset:36992
    v_lshl_add_u32 v176, v174, 3, v176
    v_add_u32 v176, s99, v176
    ds_read_b64_tr_b16 a[170:171], v240 offset:43136
    s_waitcnt vmcnt(0)
    s_barrier
    s_waitcnt lgkmcnt(12)
    v_mfma_f32_16x16x32_bf16 v[0:3], a[144:147], v[184:187], v[0:3]
    ds_read_b64_tr_b16 a[172:173], v241 offset:36992
    ds_read_b64_tr_b16 a[174:175], v241 offset:43136
    v_mov_b32 v172, v249
    v_cvt_pk_bf16_f32 v194, v196, v197
    s_waitcnt lgkmcnt(12)
    v_mfma_f32_16x16x32_bf16 v[4:7], a[148:151], v[184:187], v[4:7]
    ds_read_b64_tr_b16 a[176:177], v238 offset:37120
    ds_read_b64_tr_b16 a[178:179], v238 offset:43264
    v_permlane32_swap_b32 v249, v172
    v_cvt_pk_bf16_f32 v195, v198, v199
    v_add_f32 v249, v249, v172
    s_waitcnt lgkmcnt(12)
    v_mfma_f32_16x16x32_bf16 v[8:11], a[152:155], v[184:187], v[8:11]
    ds_read_b64_tr_b16 a[180:181], v239 offset:37120
    ds_read_b64_tr_b16 a[182:183], v239 offset:43264
    v_add_f32 v250, v250, v196
    v_mov_b32 v172, v249
    s_waitcnt lgkmcnt(12)
    v_mfma_f32_16x16x32_bf16 v[12:15], a[156:159], v[184:187], v[12:15]
    ds_read_b64_tr_b16 a[184:185], v240 offset:37120
    ds_read_b64_tr_b16 a[186:187], v240 offset:43264
    v_add_f32 v250, v250, v197
    v_permlane16_swap_b32 v249, v172
    v_add_f32 v250, v250, v198
    s_waitcnt lgkmcnt(12)
    v_mfma_f32_16x16x32_bf16 v[16:19], a[160:163], v[184:187], v[16:19]
    ds_read_b64_tr_b16 a[188:189], v241 offset:37120
    ds_read_b64_tr_b16 a[190:191], v241 offset:43264
    v_add_f32 v249, v249, v172
    v_add_f32 v250, v250, v199
    s_waitcnt lgkmcnt(12)
    v_mfma_f32_16x16x32_bf16 v[20:23], a[164:167], v[184:187], v[20:23]
    v_rcp_f32 v168, v249
    v_mov_b32 v208, 0
    v_cmp_nle_f32 s[60:61], v249, s48
    s_waitcnt lgkmcnt(10)
    v_mfma_f32_16x16x32_bf16 v[24:27], a[168:171], v[184:187], v[24:27]
    v_mov_b32 v209, 0
    v_cmp_nge_f32 s[80:81], v249, s29
    v_mov_b32 v210, 0
    s_waitcnt lgkmcnt(8)
    v_mfma_f32_16x16x32_bf16 v[28:31], a[172:175], v[184:187], v[28:31]
    s_or_b64 s[78:79], s[78:79], s[60:61]
    v_mov_b32 v211, 0
    s_waitcnt lgkmcnt(6)
    v_mfma_f32_16x16x32_bf16 v[32:35], a[176:179], v[184:187], v[32:35]
    s_or_b64 s[78:79], s[78:79], s[80:81]
    v_exp_f32 v205, v205
    v_exp_f32 v206, v206
    s_waitcnt lgkmcnt(4)
    v_mfma_f32_16x16x32_bf16 v[36:39], a[180:183], v[184:187], v[36:39]
    v_exp_f32 v207, v207
    v_cvt_pk_bf16_f32 v201, v202, v203
    s_waitcnt lgkmcnt(2)
    v_mfma_f32_16x16x32_bf16 v[40:43], a[184:187], v[184:187], v[40:43]
    v_cvt_pk_bf16_f32 v202, v204, v205
    v_cvt_pk_bf16_f32 v203, v206, v207
    v_add_f32 v251, v251, v204
    s_waitcnt lgkmcnt(0)
    v_mfma_f32_16x16x32_bf16 v[44:47], a[188:191], v[184:187], v[44:47]
    v_add_f32 v251, v251, v205
    v_add_f32 v251, v251, v206
    v_add_f32 v251, v251, v207
    s_nop 3
    s_branch L_fin
L_fin:
    s_mov_b32 s50, 384
    s_mov_b32 s51, 400
    v_lshrrev_b32 v146, 7, v245
    v_and_b32 v147, 112, v245
    v_mad_u32_u24 v145, v146, s50, v147
    v_mad_u32_u24 v144, v146, s51, v147
    v_add_u32 v144, s99, v144
    v_pk_mul_f32 v[152:153], v[0:1], v[168:169] op_sel_hi:[1,0]
    v_pk_mul_f32 v[154:155], v[2:3], v[168:169] op_sel_hi:[1,0]
    v_pk_mul_f32 v[156:157], v[4:5], v[168:169] op_sel_hi:[1,0]
    v_pk_mul_f32 v[158:159], v[6:7], v[168:169] op_sel_hi:[1,0]
    v_cvt_pk_bf16_f32 v152, v152, v153
    v_cvt_pk_bf16_f32 v153, v154, v155
    v_mfma_f32_16x16x32_bf16 v[48:51], a[144:147], v[192:195], v[48:51]
    v_cvt_pk_bf16_f32 v154, v156, v157
    v_cvt_pk_bf16_f32 v155, v158, v159
    v_mfma_f32_16x16x32_bf16 v[52:55], a[148:151], v[192:195], v[52:55]
    ds_write2_b64 v176, v[152:153], v[154:155] offset0:0 offset1:4
    v_add_f32 v250, v250, v233
    v_add_f32 v251, v251, v234
    v_add_f32 v252, v252, v235
    v_add_u32 v177, 0, v173
    v_mul_u32_u24 v174, 2731, v177
    v_lshrrev_b32 v174, 16, v174
    v_add_lshl_u32 v177, v177, v174, 4
    v_add_u32 v177, s99, v177
    v_pk_mul_f32 v[160:161], v[8:9], v[168:169] op_sel_hi:[1,0]
    v_pk_mul_f32 v[162:163], v[10:11], v[168:169] op_sel_hi:[1,0]
    v_pk_mul_f32 v[164:165], v[12:13], v[168:169] op_sel_hi:[1,0]
    v_pk_mul_f32 v[166:167], v[14:15], v[168:169] op_sel_hi:[1,0]
    v_cvt_pk_bf16_f32 v160, v160, v161
    v_cvt_pk_bf16_f32 v161, v162, v163
    v_mfma_f32_16x16x32_bf16 v[56:59], a[152:155], v[192:195], v[56:59]
    v_cvt_pk_bf16_f32 v162, v164, v165
    v_cvt_pk_bf16_f32 v163, v166, v167
    v_mfma_f32_16x16x32_bf16 v[60:63], a[156:159], v[192:195], v[60:63]
    ds_write2_b64 v176, v[160:161], v[162:163] offset0:8 offset1:12
    ds_read_b128 a[48:51], v144 offset:0
    ds_read_b128 a[52:55], v144 offset:3200
    v_add_u32 v178, 64, v173
    v_mul_u32_u24 v174, 2731, v178
    v_lshrrev_b32 v174, 16, v174
    v_add_lshl_u32 v178, v178, v174, 4
    v_add_u32 v178, s99, v178
    v_pk_mul_f32 v[152:153], v[16:17], v[168:169] op_sel_hi:[1,0]
    v_pk_mul_f32 v[154:155], v[18:19], v[168:169] op_sel_hi:[1,0]
    v_pk_mul_f32 v[156:157], v[20:21], v[168:169] op_sel_hi:[1,0]
    v_pk_mul_f32 v[158:159], v[22:23], v[168:169] op_sel_hi:[1,0]
    v_cvt_pk_bf16_f32 v152, v152, v153
    v_cvt_pk_bf16_f32 v153, v154, v155
    v_mfma_f32_16x16x32_bf16 v[64:67], a[160:163], v[192:195], v[64:67]
    v_cvt_pk_bf16_f32 v154, v156, v157
    v_cvt_pk_bf16_f32 v155, v158, v159
    v_mfma_f32_16x16x32_bf16 v[68:71], a[164:167], v[192:195], v[68:71]
    s_waitcnt lgkmcnt(0)
    buffer_store_dwordx4 a[48:51], v145, s[24:27], s32 offen offset:0 sc1 nt
    ds_write2_b64 v176, v[152:153], v[154:155] offset0:16 offset1:20
    buffer_store_dwordx4 a[52:55], v145, s[24:27], s95 offen offset:0 sc1 nt
    v_add_u32 v179, 128, v173
    v_mul_u32_u24 v174, 2731, v179
    v_lshrrev_b32 v174, 16, v174
    v_add_lshl_u32 v179, v179, v174, 4
    v_add_u32 v179, s99, v179
    v_pk_mul_f32 v[160:161], v[24:25], v[168:169] op_sel_hi:[1,0]
    v_pk_mul_f32 v[162:163], v[26:27], v[168:169] op_sel_hi:[1,0]
    v_pk_mul_f32 v[164:165], v[28:29], v[168:169] op_sel_hi:[1,0]
    v_pk_mul_f32 v[166:167], v[30:31], v[168:169] op_sel_hi:[1,0]
    v_cvt_pk_bf16_f32 v160, v160, v161
    v_cvt_pk_bf16_f32 v161, v162, v163
    v_mfma_f32_16x16x32_bf16 v[72:75], a[168:171], v[192:195], v[72:75]
    v_cvt_pk_bf16_f32 v162, v164, v165
    v_cvt_pk_bf16_f32 v163, v166, v167
    v_mfma_f32_16x16x32_bf16 v[76:79], a[172:175], v[192:195], v[76:79]
    v_mfma_f32_16x16x32_bf16 v[80:83], a[176:179], v[192:195], v[80:83]
    ds_write2_b64 v176, v[160:161], v[162:163] offset0:24 offset1:28
    ds_read_b128 a[56:59], v144 offset:128
    ds_read_b128 a[60:63], v144 offset:3328
    v_mov_b32 v173, v250
    s_nop 1
    v_permlane32_swap_b32 v250, v173
    v_add_f32 v250, v250, v173
    v_mov_b32 v173, v250
    s_nop 1
    v_permlane16_swap_b32 v250, v173
    v_pk_mul_f32 v[152:153], v[32:33], v[168:169] op_sel_hi:[1,0]
    v_pk_mul_f32 v[154:155], v[34:35], v[168:169] op_sel_hi:[1,0]
    v_pk_mul_f32 v[156:157], v[36:37], v[168:169] op_sel_hi:[1,0]
    v_pk_mul_f32 v[158:159], v[38:39], v[168:169] op_sel_hi:[1,0]
    v_cvt_pk_bf16_f32 v152, v152, v153
    v_cvt_pk_bf16_f32 v153, v154, v155
    v_mfma_f32_16x16x32_bf16 v[84:87], a[180:183], v[192:195], v[84:87]
    v_cvt_pk_bf16_f32 v154, v156, v157
    v_cvt_pk_bf16_f32 v155, v158, v159
    v_mfma_f32_16x16x32_bf16 v[88:91], a[184:187], v[192:195], v[88:91]
    v_mfma_f32_16x16x32_bf16 v[92:95], a[188:191], v[192:195], v[92:95]
    s_waitcnt lgkmcnt(0)
    buffer_store_dwordx4 a[56:59], v145, s[24:27], s32 offen offset:128 sc1 nt
    ds_write2_b64 v176, v[152:153], v[154:155] offset0:32 offset1:36
    buffer_store_dwordx4 a[60:63], v145, s[24:27], s95 offen offset:128 sc1 nt
    v_add_f32 v250, v250, v173
    v_rcp_f32 v169, v250
    v_cmp_nle_f32 s[60:61], v250, s48
    v_cmp_nge_f32 s[80:81], v250, s29
    s_nop 0
    s_or_b64 s[78:79], s[78:79], s[60:61]
    s_or_b64 s[78:79], s[78:79], s[80:81]
    v_pk_mul_f32 v[160:161], v[40:41], v[168:169] op_sel_hi:[1,0]
    v_pk_mul_f32 v[162:163], v[42:43], v[168:169] op_sel_hi:[1,0]
    v_pk_mul_f32 v[164:165], v[44:45], v[168:169] op_sel_hi:[1,0]
    v_pk_mul_f32 v[166:167], v[46:47], v[168:169] op_sel_hi:[1,0]
    v_cvt_pk_bf16_f32 v160, v160, v161
    v_cvt_pk_bf16_f32 v161, v162, v163
    v_mfma_f32_16x16x32_bf16 a[0:3], a[144:147], v[208:211], a[0:3]
    v_cvt_pk_bf16_f32 v162, v164, v165
    v_cvt_pk_bf16_f32 v163, v166, v167
    v_mfma_f32_16x16x32_bf16 a[4:7], a[148:151], v[208:211], a[4:7]
    v_mfma_f32_16x16x32_bf16 a[8:11], a[152:155], v[208:211], a[8:11]
    ds_write2_b64 v176, v[160:161], v[162:163] offset0:40 offset1:44
    ds_read_b128 a[64:67], v144 offset:256
    ds_read_b128 a[68:71], v144 offset:3456
    v_mov_b32 v174, v251
    s_nop 1
    v_permlane32_swap_b32 v251, v174
    v_pk_mul_f32 v[152:153], v[48:49], v[168:169] op_sel:[0,1] op_sel_hi:[1,1]
    v_pk_mul_f32 v[154:155], v[50:51], v[168:169] op_sel:[0,1] op_sel_hi:[1,1]
    v_pk_mul_f32 v[156:157], v[52:53], v[168:169] op_sel:[0,1] op_sel_hi:[1,1]
    v_pk_mul_f32 v[158:159], v[54:55], v[168:169] op_sel:[0,1] op_sel_hi:[1,1]
    v_cvt_pk_bf16_f32 v152, v152, v153
    v_cvt_pk_bf16_f32 v153, v154, v155
    v_mfma_f32_16x16x32_bf16 a[12:15], a[156:159], v[208:211], a[12:15]
    v_cvt_pk_bf16_f32 v154, v156, v157
    v_cvt_pk_bf16_f32 v155, v158, v159
    v_mfma_f32_16x16x32_bf16 a[16:19], a[160:163], v[208:211], a[16:19]
    v_mfma_f32_16x16x32_bf16 a[20:23], a[164:167], v[208:211], a[20:23]
    s_waitcnt lgkmcnt(0)
    buffer_store_dwordx4 a[64:67], v145, s[24:27], s32 offen offset:256 sc1 nt
    ds_write2_b64 v176, v[152:153], v[154:155] offset0:0 offset1:4
    buffer_store_dwordx4 a[68:71], v145, s[24:27], s95 offen offset:256 sc1 nt
    v_add_f32 v251, v251, v174
    v_mov_b32 v174, v251
    v_pk_mul_f32 v[160:161], v[56:57], v[168:169] op_sel:[0,1] op_sel_hi:[1,1]
    v_pk_mul_f32 v[162:163], v[58:59], v[168:169] op_sel:[0,1] op_sel_hi:[1,1]
    v_pk_mul_f32 v[164:165], v[60:61], v[168:169] op_sel:[0,1] op_sel_hi:[1,1]
    v_pk_mul_f32 v[166:167], v[62:63], v[168:169] op_sel:[0,1] op_sel_hi:[1,1]
    v_cvt_pk_bf16_f32 v160, v160, v161
    v_cvt_pk_bf16_f32 v161, v162, v163
    v_mfma_f32_16x16x32_bf16 a[24:27], a[168:171], v[208:211], a[24:27]
    v_cvt_pk_bf16_f32 v162, v164, v165
    v_cvt_pk_bf16_f32 v163, v166, v167
    v_mfma_f32_16x16x32_bf16 a[28:31], a[172:175], v[208:211], a[28:31]
    v_mfma_f32_16x16x32_bf16 a[32:35], a[176:179], v[208:211], a[32:35]
    ds_write2_b64 v176, v[160:161], v[162:163] offset0:8 offset1:12
    v_permlane16_swap_b32 v251, v174
    v_add_f32 v251, v251, v174
    v_pk_mul_f32 v[152:153], v[64:65], v[168:169] op_sel:[0,1] op_sel_hi:[1,1]
    v_pk_mul_f32 v[154:155], v[66:67], v[168:169] op_sel:[0,1] op_sel_hi:[1,1]
    v_pk_mul_f32 v[156:157], v[68:69], v[168:169] op_sel:[0,1] op_sel_hi:[1,1]
    v_pk_mul_f32 v[158:159], v[70:71], v[168:169] op_sel:[0,1] op_sel_hi:[1,1]
    v_cvt_pk_bf16_f32 v152, v152, v153
    v_cvt_pk_bf16_f32 v153, v154, v155
    v_mfma_f32_16x16x32_bf16 a[36:39], a[180:183], v[208:211], a[36:39]
    v_cvt_pk_bf16_f32 v154, v156, v157
    v_cvt_pk_bf16_f32 v155, v158, v159
    v_mfma_f32_16x16x32_bf16 a[40:43], a[184:187], v[208:211], a[40:43]
    v_mfma_f32_16x16x32_bf16 a[44:47], a[188:191], v[208:211], a[44:47]
    v_add_u32 v254, s100, v245
    ds_write_b32 v247, v252 offset:0
    ds_write_b128 v254, a[24:27] offset:0
    ds_write2_b64 v176, v[152:153], v[154:155] offset0:16 offset1:20
    v_rcp_f32 v170, v251
    v_cmp_nle_f32 s[60:61], v251, s48
    v_pk_mul_f32 v[160:161], v[72:73], v[168:169] op_sel:[0,1] op_sel_hi:[1,1]
    v_pk_mul_f32 v[162:163], v[74:75], v[168:169] op_sel:[0,1] op_sel_hi:[1,1]
    v_pk_mul_f32 v[164:165], v[76:77], v[168:169] op_sel:[0,1] op_sel_hi:[1,1]
    v_pk_mul_f32 v[166:167], v[78:79], v[168:169] op_sel:[0,1] op_sel_hi:[1,1]
    v_cvt_pk_bf16_f32 v160, v160, v161
    v_cvt_pk_bf16_f32 v161, v162, v163
    v_mfma_f32_16x16x32_bf16 v[96:99], a[144:147], v[200:203], v[96:99]
    v_cvt_pk_bf16_f32 v162, v164, v165
    v_cvt_pk_bf16_f32 v163, v166, v167
    v_mfma_f32_16x16x32_bf16 v[100:103], a[148:151], v[200:203], v[100:103]
    v_mfma_f32_16x16x32_bf16 v[104:107], a[152:155], v[200:203], v[104:107]
    v_mfma_f32_16x16x32_bf16 v[108:111], a[156:159], v[200:203], v[108:111]
    ds_write_b128 v254, a[28:31] offset:1024
    ds_write2_b64 v176, v[160:161], v[162:163] offset0:24 offset1:28
    v_cmp_nge_f32 s[80:81], v251, s29
    s_or_b64 s[78:79], s[78:79], s[60:61]
    s_nop 0
    s_or_b64 s[78:79], s[78:79], s[80:81]
    v_pk_mul_f32 v[152:153], v[80:81], v[168:169] op_sel:[0,1] op_sel_hi:[1,1]
    v_pk_mul_f32 v[154:155], v[82:83], v[168:169] op_sel:[0,1] op_sel_hi:[1,1]
    v_pk_mul_f32 v[156:157], v[84:85], v[168:169] op_sel:[0,1] op_sel_hi:[1,1]
    v_pk_mul_f32 v[158:159], v[86:87], v[168:169] op_sel:[0,1] op_sel_hi:[1,1]
    v_cvt_pk_bf16_f32 v152, v152, v153
    v_cvt_pk_bf16_f32 v153, v154, v155
    v_mfma_f32_16x16x32_bf16 v[112:115], a[160:163], v[200:203], v[112:115]
    v_cvt_pk_bf16_f32 v154, v156, v157
    v_cvt_pk_bf16_f32 v155, v158, v159
    v_mfma_f32_16x16x32_bf16 v[116:119], a[164:167], v[200:203], v[116:119]
    v_mfma_f32_16x16x32_bf16 v[120:123], a[168:171], v[200:203], v[120:123]
    v_mfma_f32_16x16x32_bf16 v[124:127], a[172:175], v[200:203], v[124:127]
    ds_write_b128 v254, a[32:35] offset:2048
    ds_write_b128 v254, a[36:39] offset:3072
    ds_write2_b64 v176, v[152:153], v[154:155] offset0:32 offset1:36
    v_pk_mul_f32 v[160:161], v[88:89], v[168:169] op_sel:[0,1] op_sel_hi:[1,1]
    v_pk_mul_f32 v[162:163], v[90:91], v[168:169] op_sel:[0,1] op_sel_hi:[1,1]
    v_pk_mul_f32 v[164:165], v[92:93], v[168:169] op_sel:[0,1] op_sel_hi:[1,1]
    v_pk_mul_f32 v[166:167], v[94:95], v[168:169] op_sel:[0,1] op_sel_hi:[1,1]
    v_cvt_pk_bf16_f32 v160, v160, v161
    v_cvt_pk_bf16_f32 v161, v162, v163
    v_mfma_f32_16x16x32_bf16 v[128:131], a[176:179], v[200:203], v[128:131]
    v_cvt_pk_bf16_f32 v162, v164, v165
    v_cvt_pk_bf16_f32 v163, v166, v167
    v_mfma_f32_16x16x32_bf16 v[132:135], a[180:183], v[200:203], v[132:135]
    v_mfma_f32_16x16x32_bf16 v[136:139], a[184:187], v[200:203], v[136:139]
    v_mfma_f32_16x16x32_bf16 v[140:143], a[188:191], v[200:203], v[140:143]
    ds_write_b128 v254, a[40:43] offset:4096
    ds_write_b128 v254, a[44:47] offset:5120
    ds_write2_b64 v176, v[160:161], v[162:163] offset0:40 offset1:44
    ds_read_b128 a[72:75], v177 offset:0
    ds_read_b128 a[76:79], v178 offset:0
    ds_read_b128 a[80:83], v179 offset:0
    ds_read_b128 a[84:87], v177 offset:3200
    ds_read_b128 a[88:91], v178 offset:3200
    ds_read_b128 a[92:95], v179 offset:3200
    v_pk_mul_f32 v[152:153], v[96:97], v[170:171] op_sel_hi:[1,0]
    v_pk_mul_f32 v[154:155], v[98:99], v[170:171] op_sel_hi:[1,0]
    v_pk_mul_f32 v[156:157], v[100:101], v[170:171] op_sel_hi:[1,0]
    v_pk_mul_f32 v[158:159], v[102:103], v[170:171] op_sel_hi:[1,0]
    v_cvt_pk_bf16_f32 v152, v152, v153
    v_cvt_pk_bf16_f32 v153, v154, v155
    v_cvt_pk_bf16_f32 v154, v156, v157
    v_cvt_pk_bf16_f32 v155, v158, v159
    s_waitcnt lgkmcnt(0)
    s_barrier
    v_xor_b32 v254, 256, v247
    ds_read_b32 v175, v254 offset:0
    v_add_u32 v254, s101, v245
    ds_read_b128 v[0:3], v254 offset:0
    ds_read_b128 v[4:7], v254 offset:1024
    ds_read_b128 v[8:11], v254 offset:2048
    ds_read_b128 v[12:15], v254 offset:3072
    ds_read_b128 v[16:19], v254 offset:4096
    ds_read_b128 v[20:23], v254 offset:5120
    ds_write2_b64 v176, v[152:153], v[154:155] offset0:0 offset1:4
    v_pk_mul_f32 v[160:161], v[104:105], v[170:171] op_sel_hi:[1,0]
    v_pk_mul_f32 v[162:163], v[106:107], v[170:171] op_sel_hi:[1,0]
    v_pk_mul_f32 v[164:165], v[108:109], v[170:171] op_sel_hi:[1,0]
    v_pk_mul_f32 v[166:167], v[110:111], v[170:171] op_sel_hi:[1,0]
    v_cvt_pk_bf16_f32 v160, v160, v161
    v_cvt_pk_bf16_f32 v161, v162, v163
    v_cvt_pk_bf16_f32 v162, v164, v165
    v_cvt_pk_bf16_f32 v163, v166, v167
    buffer_store_dwordx4 a[72:75], v245, s[24:27], s33 offen offset:0 sc1 nt
    ds_write2_b64 v176, v[160:161], v[162:163] offset0:8 offset1:12
    v_pk_mul_f32 v[152:153], v[112:113], v[170:171] op_sel_hi:[1,0]
    v_pk_mul_f32 v[154:155], v[114:115], v[170:171] op_sel_hi:[1,0]
    v_pk_mul_f32 v[156:157], v[116:117], v[170:171] op_sel_hi:[1,0]
    v_pk_mul_f32 v[158:159], v[118:119], v[170:171] op_sel_hi:[1,0]
    v_cvt_pk_bf16_f32 v152, v152, v153
    v_cvt_pk_bf16_f32 v153, v154, v155
    v_cvt_pk_bf16_f32 v154, v156, v157
    v_cvt_pk_bf16_f32 v155, v158, v159
    buffer_store_dwordx4 a[76:79], v245, s[24:27], s33 offen offset:1024 sc1 nt
    s_waitcnt lgkmcnt(2)
    ds_write2_b64 v176, v[152:153], v[154:155] offset0:16 offset1:20
    v_add_f32 v252, v252, v175
    v_mov_b32 v172, v252
    s_nop 1
    v_permlane32_swap_b32 v252, v172
    v_add_f32 v252, v252, v172
    v_pk_mul_f32 v[160:161], v[120:121], v[170:171] op_sel_hi:[1,0]
    v_pk_mul_f32 v[162:163], v[122:123], v[170:171] op_sel_hi:[1,0]
    v_pk_mul_f32 v[164:165], v[124:125], v[170:171] op_sel_hi:[1,0]
    v_pk_mul_f32 v[166:167], v[126:127], v[170:171] op_sel_hi:[1,0]
    v_cvt_pk_bf16_f32 v160, v160, v161
    v_cvt_pk_bf16_f32 v161, v162, v163
    v_cvt_pk_bf16_f32 v162, v164, v165
    v_cvt_pk_bf16_f32 v163, v166, v167
    buffer_store_dwordx4 a[80:83], v245, s[24:27], s33 offen offset:2048 sc1 nt
    ds_write2_b64 v176, v[160:161], v[162:163] offset0:24 offset1:28
    v_mov_b32 v172, v252
    s_nop 1
    v_permlane16_swap_b32 v252, v172
    v_add_f32 v252, v252, v172
    v_rcp_f32 v171, v252
    v_pk_mul_f32 v[152:153], v[128:129], v[170:171] op_sel_hi:[1,0]
    v_pk_mul_f32 v[154:155], v[130:131], v[170:171] op_sel_hi:[1,0]
    v_pk_mul_f32 v[156:157], v[132:133], v[170:171] op_sel_hi:[1,0]
    v_pk_mul_f32 v[158:159], v[134:135], v[170:171] op_sel_hi:[1,0]
    v_cvt_pk_bf16_f32 v152, v152, v153
    v_cvt_pk_bf16_f32 v153, v154, v155
    v_cvt_pk_bf16_f32 v154, v156, v157
    v_cvt_pk_bf16_f32 v155, v158, v159
    buffer_store_dwordx4 a[84:87], v245, s[24:27], s96 offen offset:0 sc1 nt
    s_barrier
    ds_write2_b64 v176, v[152:153], v[154:155] offset0:32 offset1:36
    v_cmp_nle_f32 s[60:61], v252, s48
    v_cmp_nge_f32 s[80:81], v252, s29
    s_nop 0
    s_or_b64 s[78:79], s[78:79], s[60:61]
    s_or_b64 s[78:79], s[78:79], s[80:81]
    v_pk_mul_f32 v[160:161], v[136:137], v[170:171] op_sel_hi:[1,0]
    v_pk_mul_f32 v[162:163], v[138:139], v[170:171] op_sel_hi:[1,0]
    v_pk_mul_f32 v[164:165], v[140:141], v[170:171] op_sel_hi:[1,0]
    v_pk_mul_f32 v[166:167], v[142:143], v[170:171] op_sel_hi:[1,0]
    v_cvt_pk_bf16_f32 v160, v160, v161
    v_cvt_pk_bf16_f32 v161, v162, v163
    v_cvt_pk_bf16_f32 v162, v164, v165
    v_cvt_pk_bf16_f32 v163, v166, v167
    buffer_store_dwordx4 a[88:91], v245, s[24:27], s96 offen offset:1024 sc1 nt
    buffer_store_dwordx4 a[92:95], v245, s[24:27], s96 offen offset:2048 sc1 nt
    ds_write2_b64 v176, v[160:161], v[162:163] offset0:40 offset1:44
    v_accvgpr_read_b32 v152, a0
    v_accvgpr_read_b32 v153, a1
    v_accvgpr_read_b32 v154, a2
    v_accvgpr_read_b32 v155, a3
    v_accvgpr_read_b32 v156, a4
    v_accvgpr_read_b32 v157, a5
    v_accvgpr_read_b32 v158, a6
    v_accvgpr_read_b32 v159, a7
    ds_read_b128 a[96:99], v177 offset:0
    ds_read_b128 a[100:103], v178 offset:0
    ds_read_b128 a[104:107], v179 offset:0
    ds_read_b128 a[108:111], v177 offset:3200
    ds_read_b128 a[112:115], v178 offset:3200
    ds_read_b128 a[116:119], v179 offset:3200
    v_add_u32 v254, s49, v176
    v_pk_add_f32 v[152:153], v[152:153], v[0:1]
    v_pk_add_f32 v[154:155], v[154:155], v[2:3]
    v_pk_add_f32 v[156:157], v[156:157], v[4:5]
    v_pk_add_f32 v[158:159], v[158:159], v[6:7]
    v_pk_mul_f32 v[152:153], v[152:153], v[170:171] op_sel:[0,1] op_sel_hi:[1,1]
    v_pk_mul_f32 v[154:155], v[154:155], v[170:171] op_sel:[0,1] op_sel_hi:[1,1]
    v_pk_mul_f32 v[156:157], v[156:157], v[170:171] op_sel:[0,1] op_sel_hi:[1,1]
    v_pk_mul_f32 v[158:159], v[158:159], v[170:171] op_sel:[0,1] op_sel_hi:[1,1]
    v_cvt_pk_bf16_f32 v152, v152, v153
    v_cvt_pk_bf16_f32 v153, v154, v155
    v_cvt_pk_bf16_f32 v154, v156, v157
    v_cvt_pk_bf16_f32 v155, v158, v159
    ds_write2_b64 v254, v[152:153], v[154:155] offset0:0 offset1:4
    v_accvgpr_read_b32 v160, a8
    v_accvgpr_read_b32 v161, a9
    v_accvgpr_read_b32 v162, a10
    v_accvgpr_read_b32 v163, a11
    v_accvgpr_read_b32 v164, a12
    v_accvgpr_read_b32 v165, a13
    v_accvgpr_read_b32 v166, a14
    v_accvgpr_read_b32 v167, a15
    v_pk_add_f32 v[160:161], v[160:161], v[8:9]
    v_pk_add_f32 v[162:163], v[162:163], v[10:11]
    v_pk_add_f32 v[164:165], v[164:165], v[12:13]
    v_pk_add_f32 v[166:167], v[166:167], v[14:15]
    v_pk_mul_f32 v[160:161], v[160:161], v[170:171] op_sel:[0,1] op_sel_hi:[1,1]
    v_pk_mul_f32 v[162:163], v[162:163], v[170:171] op_sel:[0,1] op_sel_hi:[1,1]
    v_pk_mul_f32 v[164:165], v[164:165], v[170:171] op_sel:[0,1] op_sel_hi:[1,1]
    v_pk_mul_f32 v[166:167], v[166:167], v[170:171] op_sel:[0,1] op_sel_hi:[1,1]
    v_cvt_pk_bf16_f32 v160, v160, v161
    v_cvt_pk_bf16_f32 v161, v162, v163
    v_cvt_pk_bf16_f32 v162, v164, v165
    v_cvt_pk_bf16_f32 v163, v166, v167
    s_waitcnt lgkmcnt(1)
    buffer_store_dwordx4 a[96:99], v245, s[24:27], s34 offen offset:0 sc1 nt
    buffer_store_dwordx4 a[100:103], v245, s[24:27], s34 offen offset:1024 sc1 nt
    ds_write2_b64 v254, v[160:161], v[162:163] offset0:8 offset1:12
    v_accvgpr_read_b32 v152, a16
    v_accvgpr_read_b32 v153, a17
    v_accvgpr_read_b32 v154, a18
    v_accvgpr_read_b32 v155, a19
    v_accvgpr_read_b32 v156, a20
    v_accvgpr_read_b32 v157, a21
    v_accvgpr_read_b32 v158, a22
    v_accvgpr_read_b32 v159, a23
    v_pk_add_f32 v[152:153], v[152:153], v[16:17]
    v_pk_add_f32 v[154:155], v[154:155], v[18:19]
    v_pk_add_f32 v[156:157], v[156:157], v[20:21]
    v_pk_add_f32 v[158:159], v[158:159], v[22:23]
    v_pk_mul_f32 v[152:153], v[152:153], v[170:171] op_sel:[0,1] op_sel_hi:[1,1]
    v_pk_mul_f32 v[154:155], v[154:155], v[170:171] op_sel:[0,1] op_sel_hi:[1,1]
    v_pk_mul_f32 v[156:157], v[156:157], v[170:171] op_sel:[0,1] op_sel_hi:[1,1]
    v_pk_mul_f32 v[158:159], v[158:159], v[170:171] op_sel:[0,1] op_sel_hi:[1,1]
    v_cvt_pk_bf16_f32 v152, v152, v153
    v_cvt_pk_bf16_f32 v153, v154, v155
    v_cvt_pk_bf16_f32 v154, v156, v157
    v_cvt_pk_bf16_f32 v155, v158, v159
    buffer_store_dwordx4 a[104:107], v245, s[24:27], s34 offen offset:2048 sc1 nt
    buffer_store_dwordx4 a[108:111], v245, s[24:27], s97 offen offset:0 sc1 nt
    ds_write2_b64 v254, v[152:153], v[154:155] offset0:16 offset1:20
    s_waitcnt lgkmcnt(0)
    s_barrier
    v_add_u32 v254, s30, v177
    ds_read_b128 a[120:123], v254 offset:0
    v_add_u32 v254, s30, v178
    ds_read_b128 a[124:127], v254 offset:0
    v_add_u32 v254, s30, v179
    ds_read_b128 a[128:131], v254 offset:0
    buffer_store_dwordx4 a[112:115], v245, s[24:27], s97 offen offset:1024 sc1 nt
    buffer_store_dwordx4 a[116:119], v245, s[24:27], s97 offen offset:2048 sc1 nt
    s_waitcnt lgkmcnt(0)
    buffer_store_dwordx4 a[120:123], v245, s[24:27], s98 offen offset:0 sc1 nt
    buffer_store_dwordx4 a[124:127], v245, s[24:27], s98 offen offset:1024 sc1 nt
    buffer_store_dwordx4 a[128:131], v245, s[24:27], s98 offen offset:2048 sc1 nt
L_done:
    s_or_b32 s47, s78, s79
    s_waitcnt vmcnt(0)
    s_barrier
    s_or_b32 s50, s46, s47
    s_cbranch_scc1 L_slow
L_end:
    s_endpgm
    .p2align 6
L_e_body:
    s_waitcnt lgkmcnt(0)
    v_mfma_f32_16x16x32_bf16 v[184:187], a[232:235], a[144:147], v[216:219]
    ds_read_b128 a[240:243], v236 offset:128
    v_mfma_f32_16x16x32_bf16 v[192:195], a[232:235], a[168:171], v[220:223]
    ds_read_b128 a[244:247], v237 offset:128
    v_mfma_f32_16x16x32_bf16 v[200:203], a[232:235], a[192:195], v[224:227]
    ds_read_b128 a[248:251], v236 offset:256
    v_mfma_f32_16x16x32_bf16 v[208:211], a[232:235], a[216:219], v[228:231]
    v_mfma_f32_16x16x32_bf16 v[208:211], a[236:239], a[220:223], v[208:211]
    ds_read_b128 a[252:255], v237 offset:256
    v_add_u32 v240, s41, v240
    v_mfma_f32_16x16x32_bf16 v[200:203], a[236:239], a[196:199], v[200:203]
    s_add_u32 m0, s40, 0
    v_add_u32 v241, s41, v241
    v_add_f32 v234, v234, v171
    v_mfma_f32_16x16x32_bf16 v[192:195], a[236:239], a[172:175], v[192:195]
    buffer_load_dwordx4 v242, s[72:75], s36 offen offset:0 nt lds
    v_mfma_f32_16x16x32_bf16 v[184:187], a[236:239], a[148:151], v[184:187]
    s_waitcnt lgkmcnt(3)
    v_exp_f32 v172, v172
    v_mfma_f32_16x16x32_bf16 v[184:187], a[240:243], a[152:155], v[184:187]
    ds_read_b128 a[232:235], v236 offset:6144
    v_cvt_pk_bf16_f32 v169, v170, v171
    v_mfma_f32_16x16x32_bf16 v[192:195], a[240:243], a[176:179], v[192:195]
    s_add_u32 m0, s40, 0
    v_exp_f32 v173, v173
    v_mfma_f32_16x16x32_bf16 v[200:203], a[240:243], a[200:203], v[200:203]
    buffer_load_dwordx4 v246, s[72:75], s36 offen offset:1024 nt lds
    v_mfma_f32_16x16x32_bf16 v[208:211], a[240:243], a[224:227], v[208:211]
    s_waitcnt lgkmcnt(3)
    v_exp_f32 v174, v174
    v_mfma_f32_16x16x32_bf16 v[208:211], a[244:247], a[228:231], v[208:211]
    ds_read_b128 a[236:239], v237 offset:6144
    v_cvt_pk_bf16_f32 v154, v156, v157
    v_mfma_f32_16x16x32_bf16 v[200:203], a[244:247], a[204:207], v[200:203]
    s_add_u32 m0, s40, 0
    v_exp_f32 v175, v175
    v_mfma_f32_16x16x32_bf16 v[192:195], a[244:247], a[180:183], v[192:195]
    buffer_load_dwordx4 v253, s[72:75], s36 offen offset:2048 nt lds
    v_mfma_f32_16x16x32_bf16 v[184:187], a[244:247], a[156:159], v[184:187]
    s_waitcnt lgkmcnt(2)
    v_cvt_pk_bf16_f32 v155, v158, v159
    v_mfma_f32_16x16x32_bf16 v[184:187], a[248:251], a[160:163], v[184:187]
    ds_read_b128 a[240:243], v236 offset:6272
    v_cvt_pk_bf16_f32 v162, v164, v165
    v_mfma_f32_16x16x32_bf16 v[192:195], a[248:251], a[184:187], v[192:195]
    s_add_u32 m0, s40, 12288
    v_cvt_pk_bf16_f32 v163, v166, v167
    v_mfma_f32_16x16x32_bf16 v[200:203], a[248:251], a[208:211], v[200:203]
    buffer_load_dwordx4 v242, s[72:75], s37 offen offset:0 nt lds
    v_mfma_f32_16x16x32_bf16 v[208:211], a[248:251], v[144:147], v[208:211]
    s_add_u32 m0, s40, 12288
    v_cvt_pk_bf16_f32 v170, v172, v173
    v_mfma_f32_16x16x32_bf16 v[208:211], a[252:255], v[148:151], v[208:211]
    ds_read_b128 a[244:247], v237 offset:6272
    v_cvt_pk_bf16_f32 v171, v174, v175
    v_mfma_f32_16x16x32_bf16 v[200:203], a[252:255], a[212:215], v[200:203]
    buffer_load_dwordx4 v246, s[72:75], s37 offen offset:1024 nt lds
    v_mfma_f32_16x16x32_bf16 v[192:195], a[252:255], a[188:191], v[192:195]
    s_add_u32 m0, s40, 12288
    v_add_f32 v232, v232, v156
    v_mfma_f32_16x16x32_bf16 v[184:187], a[252:255], a[164:167], v[184:187]
    s_waitcnt lgkmcnt(2)
    v_add_f32 v232, v232, v157
    v_mfma_f32_16x16x32_bf16 v[188:191], a[232:235], a[144:147], v[216:219]
    ds_read_b128 a[248:251], v236 offset:6400
    v_add_f32 v232, v232, v158
    v_mfma_f32_16x16x32_bf16 v[196:199], a[232:235], a[168:171], v[220:223]
    buffer_load_dwordx4 v253, s[72:75], s37 offen offset:2048 nt lds
    v_mfma_f32_16x16x32_bf16 v[204:207], a[232:235], a[192:195], v[224:227]
    s_add_u32 m0, s38, 0
    v_add_f32 v232, v232, v159
    v_mfma_f32_16x16x32_bf16 v[212:215], a[232:235], a[216:219], v[228:231]
    buffer_load_dwordx4 v242, s[84:87], s36 offen offset:0 nt lds
    v_mfma_f32_16x16x32_bf16 v[212:215], a[236:239], a[220:223], v[212:215]
    ds_read_b128 a[252:255], v237 offset:6400
    v_add_f32 v233, v233, v164
    v_mfma_f32_16x16x32_bf16 v[204:207], a[236:239], a[196:199], v[204:207]
    v_add_f32 v233, v233, v165
    v_mfma_f32_16x16x32_bf16 v[196:199], a[236:239], a[172:175], v[196:199]
    v_add_f32 v233, v233, v166
    v_mfma_f32_16x16x32_bf16 v[188:191], a[236:239], a[148:151], v[188:191]
    s_waitcnt lgkmcnt(2)
    v_exp_f32 v184, v184
    v_mfma_f32_16x16x32_bf16 v[188:191], a[240:243], a[152:155], v[188:191]
    ds_read_b64_tr_b16 a[232:233], v238 offset:24576
    v_add_f32 v233, v233, v167
    v_mfma_f32_16x16x32_bf16 v[196:199], a[240:243], a[176:179], v[196:199]
    ds_read_b64_tr_b16 a[234:235], v238 offset:30720
    v_add_f32 v234, v234, v172
    v_mfma_f32_16x16x32_bf16 v[204:207], a[240:243], a[200:203], v[204:207]
    v_exp_f32 v185, v185
    v_mfma_f32_16x16x32_bf16 v[212:215], a[240:243], a[224:227], v[212:215]
    v_exp_f32 v186, v186
    v_mfma_f32_16x16x32_bf16 v[212:215], a[244:247], a[228:231], v[212:215]
    ds_read_b64_tr_b16 a[236:237], v239 offset:24576
    v_add_f32 v234, v234, v173
    v_mfma_f32_16x16x32_bf16 v[204:207], a[244:247], a[204:207], v[204:207]
    ds_read_b64_tr_b16 a[238:239], v239 offset:30720
    v_add_f32 v234, v234, v174
    v_mfma_f32_16x16x32_bf16 v[196:199], a[244:247], a[180:183], v[196:199]
    v_exp_f32 v187, v187
    v_mfma_f32_16x16x32_bf16 v[188:191], a[244:247], a[156:159], v[188:191]
    s_waitcnt lgkmcnt(4)
    v_add_f32 v234, v234, v175
    v_add_f32 v249, v249, v184
    v_mfma_f32_16x16x32_bf16 v[188:191], a[248:251], a[160:163], v[188:191]
    ds_read_b64_tr_b16 a[240:241], v240 offset:24576
    v_add_f32 v249, v249, v185
    v_mfma_f32_16x16x32_bf16 v[196:199], a[248:251], a[184:187], v[196:199]
    ds_read_b64_tr_b16 a[242:243], v240 offset:30720
    v_cvt_pk_bf16_f32 v184, v184, v185
    v_mfma_f32_16x16x32_bf16 v[204:207], a[248:251], a[208:211], v[204:207]
    v_exp_f32 v192, v192
    v_mfma_f32_16x16x32_bf16 v[212:215], a[248:251], v[144:147], v[212:215]
    v_exp_f32 v193, v193
    v_mfma_f32_16x16x32_bf16 v[212:215], a[252:255], v[148:151], v[212:215]
    ds_read_b64_tr_b16 a[244:245], v241 offset:24576
    v_add_f32 v249, v249, v186
    v_mfma_f32_16x16x32_bf16 v[204:207], a[252:255], a[212:215], v[204:207]
    ds_read_b64_tr_b16 a[246:247], v241 offset:30720
    v_add_f32 v249, v249, v187
    v_mfma_f32_16x16x32_bf16 v[196:199], a[252:255], a[188:191], v[196:199]
    v_exp_f32 v194, v194
    v_mfma_f32_16x16x32_bf16 v[188:191], a[252:255], a[164:167], v[188:191]
    s_waitcnt lgkmcnt(4)
    v_exp_f32 v195, v195
L_e_p2:
    v_mfma_f32_16x16x32_bf16 v[0:3], a[232:235], v[152:155], v[0:3]
    ds_read_b64_tr_b16 a[248:249], v238 offset:24704
    v_cvt_pk_bf16_f32 v185, v186, v187
    v_mfma_f32_16x16x32_bf16 v[48:51], a[232:235], v[160:163], v[48:51]
    ds_read_b64_tr_b16 a[250:251], v238 offset:30848
    v_add_f32 v250, v250, v192
    v_mfma_f32_16x16x32_bf16 v[96:99], a[232:235], v[168:171], v[96:99]
    v_exp_f32 v200, v200
    v_mfma_f32_16x16x32_bf16 v[100:103], a[236:239], v[168:171], v[100:103]
    ds_read_b64_tr_b16 a[252:253], v239 offset:24704
    v_add_f32 v250, v250, v193
    v_mfma_f32_16x16x32_bf16 v[52:55], a[236:239], v[160:163], v[52:55]
    ds_read_b64_tr_b16 a[254:255], v239 offset:30848
    v_cvt_pk_bf16_f32 v192, v192, v193
    v_mfma_f32_16x16x32_bf16 v[4:7], a[236:239], v[152:155], v[4:7]
    s_waitcnt lgkmcnt(4)
    v_exp_f32 v201, v201
    v_mfma_f32_16x16x32_bf16 v[8:11], a[240:243], v[152:155], v[8:11]
    ds_read_b64_tr_b16 a[232:233], v240 offset:24704
    v_add_f32 v250, v250, v194
    v_mfma_f32_16x16x32_bf16 v[56:59], a[240:243], v[160:163], v[56:59]
    ds_read_b64_tr_b16 a[234:235], v240 offset:30848
    v_add_f32 v250, v250, v195
    v_mfma_f32_16x16x32_bf16 v[104:107], a[240:243], v[168:171], v[104:107]
    v_exp_f32 v202, v202
    v_mfma_f32_16x16x32_bf16 v[108:111], a[244:247], v[168:171], v[108:111]
    ds_read_b64_tr_b16 a[236:237], v241 offset:24704
    v_cvt_pk_bf16_f32 v193, v194, v195
    v_mfma_f32_16x16x32_bf16 v[60:63], a[244:247], v[160:163], v[60:63]
    ds_read_b64_tr_b16 a[238:239], v241 offset:30848
    v_add_f32 v251, v251, v200
    v_mfma_f32_16x16x32_bf16 v[12:15], a[244:247], v[152:155], v[12:15]
    s_waitcnt lgkmcnt(4)
    v_exp_f32 v203, v203
    v_mfma_f32_16x16x32_bf16 v[16:19], a[248:251], v[152:155], v[16:19]
    ds_read_b64_tr_b16 a[240:241], v238 offset:24832
    v_add_f32 v251, v251, v201
    v_mfma_f32_16x16x32_bf16 v[64:67], a[248:251], v[160:163], v[64:67]
    ds_read_b64_tr_b16 a[242:243], v238 offset:30976
    v_cvt_pk_bf16_f32 v200, v200, v201
    v_mfma_f32_16x16x32_bf16 v[112:115], a[248:251], v[168:171], v[112:115]
    v_exp_f32 v208, v208
    v_mfma_f32_16x16x32_bf16 v[116:119], a[252:255], v[168:171], v[116:119]
    ds_read_b64_tr_b16 a[244:245], v239 offset:24832
    v_add_f32 v251, v251, v202
    v_mfma_f32_16x16x32_bf16 v[68:71], a[252:255], v[160:163], v[68:71]
    ds_read_b64_tr_b16 a[246:247], v239 offset:30976
    v_add_f32 v251, v251, v203
    v_mfma_f32_16x16x32_bf16 v[20:23], a[252:255], v[152:155], v[20:23]
    s_waitcnt lgkmcnt(4)
    v_exp_f32 v209, v209
    v_mfma_f32_16x16x32_bf16 v[24:27], a[232:235], v[152:155], v[24:27]
    ds_read_b64_tr_b16 a[248:249], v240 offset:24832
    v_cvt_pk_bf16_f32 v201, v202, v203
    v_mfma_f32_16x16x32_bf16 v[72:75], a[232:235], v[160:163], v[72:75]
    ds_read_b64_tr_b16 a[250:251], v240 offset:30976
    v_add_f32 v252, v252, v208
    v_mfma_f32_16x16x32_bf16 v[120:123], a[232:235], v[168:171], v[120:123]
    v_exp_f32 v210, v210
    v_mfma_f32_16x16x32_bf16 v[124:127], a[236:239], v[168:171], v[124:127]
    ds_read_b64_tr_b16 a[252:253], v241 offset:24832
    v_add_f32 v252, v252, v209
    v_mfma_f32_16x16x32_bf16 v[76:79], a[236:239], v[160:163], v[76:79]
    ds_read_b64_tr_b16 a[254:255], v241 offset:30976
    v_cvt_pk_bf16_f32 v208, v208, v209
    v_mfma_f32_16x16x32_bf16 v[28:31], a[236:239], v[152:155], v[28:31]
    s_waitcnt lgkmcnt(4)
    v_exp_f32 v211, v211
    v_mfma_f32_16x16x32_bf16 v[32:35], a[240:243], v[152:155], v[32:35]
    ds_read_b128 a[232:235], v236 offset:12288
    v_add_f32 v252, v252, v210
    v_mfma_f32_16x16x32_bf16 v[80:83], a[240:243], v[160:163], v[80:83]
    v_exp_f32 v188, v188
    v_mfma_f32_16x16x32_bf16 v[128:131], a[240:243], v[168:171], v[128:131]
    v_exp_f32 v189, v189
    v_mfma_f32_16x16x32_bf16 v[132:135], a[244:247], v[168:171], v[132:135]
    ds_read_b128 a[236:239], v237 offset:12288
    v_add_f32 v252, v252, v211
    v_mfma_f32_16x16x32_bf16 v[84:87], a[244:247], v[160:163], v[84:87]
    v_exp_f32 v190, v190
    v_mfma_f32_16x16x32_bf16 v[36:39], a[244:247], v[152:155], v[36:39]
    s_waitcnt lgkmcnt(2)
    v_exp_f32 v191, v191
    v_mfma_f32_16x16x32_bf16 v[40:43], a[248:251], v[152:155], v[40:43]
    ds_read_b128 a[240:243], v236 offset:12416
    v_cvt_pk_bf16_f32 v209, v210, v211
    v_mfma_f32_16x16x32_bf16 v[88:91], a[248:251], v[160:163], v[88:91]
    v_exp_f32 v196, v196
    v_mfma_f32_16x16x32_bf16 v[136:139], a[248:251], v[168:171], v[136:139]
    v_exp_f32 v197, v197
    v_mfma_f32_16x16x32_bf16 v[140:143], a[252:255], v[168:171], v[140:143]
    ds_read_b128 a[244:247], v237 offset:12416
    v_cvt_pk_bf16_f32 v186, v188, v189
    v_mfma_f32_16x16x32_bf16 v[92:95], a[252:255], v[160:163], v[92:95]
    s_waitcnt lgkmcnt(2)
    v_exp_f32 v198, v198
    v_mfma_f32_16x16x32_bf16 v[44:47], a[252:255], v[152:155], v[44:47]
    s_cbranch_vccnz L_e_exit
L_e_mid:
    v_exp_f32 v199, v199
    v_mfma_f32_16x16x32_bf16 v[152:155], a[232:235], a[144:147], v[216:219]
    ds_read_b128 a[248:251], v236 offset:12544
    v_cvt_pk_bf16_f32 v187, v190, v191
    v_mfma_f32_16x16x32_bf16 v[160:163], a[232:235], a[168:171], v[220:223]
    s_sub_u32 s41, s42, s39
    v_exp_f32 v204, v204
    v_mfma_f32_16x16x32_bf16 v[168:171], a[232:235], a[192:195], v[224:227]
    s_mov_b32 s59, s39
    v_exp_f32 v205, v205
    v_mfma_f32_16x16x32_bf16 v[168:171], a[236:239], a[196:199], v[168:171]
    ds_read_b128 a[252:255], v237 offset:12544
    v_cvt_pk_bf16_f32 v194, v196, v197
    v_mfma_f32_16x16x32_bf16 v[160:163], a[236:239], a[172:175], v[160:163]
    s_mov_b32 s39, s42
    v_exp_f32 v206, v206
    v_mfma_f32_16x16x32_bf16 v[152:155], a[236:239], a[148:151], v[152:155]
    s_waitcnt lgkmcnt(2)
    v_exp_f32 v207, v207
    v_mfma_f32_16x16x32_bf16 v[152:155], a[240:243], a[152:155], v[152:155]
    ds_read_b128 a[232:235], v236 offset:18432
    v_cvt_pk_bf16_f32 v195, v198, v199
    v_mfma_f32_16x16x32_bf16 v[160:163], a[240:243], a[176:179], v[160:163]
    s_mov_b32 s42, s31
    v_exp_f32 v212, v212
    v_mfma_f32_16x16x32_bf16 v[168:171], a[240:243], a[200:203], v[168:171]
    s_mov_b32 s31, s59
    v_exp_f32 v213, v213
    v_mfma_f32_16x16x32_bf16 v[168:171], a[244:247], a[204:207], v[168:171]
    ds_read_b128 a[236:239], v237 offset:18432
    v_cvt_pk_bf16_f32 v202, v204, v205
    v_mfma_f32_16x16x32_bf16 v[160:163], a[244:247], a[180:183], v[160:163]
    s_add_u32 s40, s31, s70
    v_exp_f32 v214, v214
    v_mfma_f32_16x16x32_bf16 v[152:155], a[244:247], a[156:159], v[152:155]
    s_waitcnt lgkmcnt(2)
    v_exp_f32 v215, v215
    v_mfma_f32_16x16x32_bf16 v[152:155], a[248:251], a[160:163], v[152:155]
    ds_read_b128 a[240:243], v236 offset:18560
    v_cvt_pk_bf16_f32 v203, v206, v207
    v_mfma_f32_16x16x32_bf16 v[160:163], a[248:251], a[184:187], v[160:163]
    v_cvt_pk_bf16_f32 v210, v212, v213
    v_mfma_f32_16x16x32_bf16 v[168:171], a[248:251], a[208:211], v[168:171]
    v_cvt_pk_bf16_f32 v211, v214, v215
    v_mfma_f32_16x16x32_bf16 v[168:171], a[252:255], a[212:215], v[168:171]
    ds_read_b128 a[244:247], v237 offset:18560
    v_add_f32 v249, v249, v188
    v_mfma_f32_16x16x32_bf16 v[160:163], a[252:255], a[188:191], v[160:163]
    v_add_f32 v249, v249, v189
    v_mfma_f32_16x16x32_bf16 v[152:155], a[252:255], a[164:167], v[152:155]
    s_waitcnt lgkmcnt(2)
    v_add_f32 v249, v249, v190
    v_mfma_f32_16x16x32_bf16 v[156:159], a[232:235], a[144:147], v[216:219]
    ds_read_b128 a[248:251], v236 offset:18688
    v_add_f32 v249, v249, v191
    v_mfma_f32_16x16x32_bf16 v[164:167], a[232:235], a[168:171], v[220:223]
    v_add_f32 v250, v250, v196
    v_mfma_f32_16x16x32_bf16 v[172:175], a[232:235], a[192:195], v[224:227]
    v_add_f32 v250, v250, v197
    v_mfma_f32_16x16x32_bf16 v[172:175], a[236:239], a[196:199], v[172:175]
    ds_read_b128 a[252:255], v237 offset:18688
    v_add_f32 v250, v250, v198
    v_mfma_f32_16x16x32_bf16 v[164:167], a[236:239], a[172:175], v[164:167]
    v_add_f32 v250, v250, v199
    v_mfma_f32_16x16x32_bf16 v[156:159], a[236:239], a[148:151], v[156:159]
    s_waitcnt lgkmcnt(2)
    v_add_u32 v236, s41, v236
    v_mfma_f32_16x16x32_bf16 v[156:159], a[240:243], a[152:155], v[156:159]
    ds_read_b64_tr_b16 a[232:233], v238 offset:36864
    v_add_f32 v251, v251, v204
    v_mfma_f32_16x16x32_bf16 v[164:167], a[240:243], a[176:179], v[164:167]
    ds_read_b64_tr_b16 a[234:235], v238 offset:43008
    v_add_u32 v237, s41, v237
    v_mfma_f32_16x16x32_bf16 v[172:175], a[240:243], a[200:203], v[172:175]
    v_exp_f32 v152, v152
    v_mfma_f32_16x16x32_bf16 v[172:175], a[244:247], a[204:207], v[172:175]
    ds_read_b64_tr_b16 a[236:237], v239 offset:36864
    v_add_f32 v251, v251, v205
    v_mfma_f32_16x16x32_bf16 v[164:167], a[244:247], a[180:183], v[164:167]
    ds_read_b64_tr_b16 a[238:239], v239 offset:43008
    v_add_f32 v251, v251, v206
    v_mfma_f32_16x16x32_bf16 v[156:159], a[244:247], a[156:159], v[156:159]
    s_waitcnt lgkmcnt(4)
    v_exp_f32 v153, v153
    v_mfma_f32_16x16x32_bf16 v[156:159], a[248:251], a[160:163], v[156:159]
    ds_read_b64_tr_b16 a[240:241], v240 offset:36864
    v_add_f32 v251, v251, v207
    v_mfma_f32_16x16x32_bf16 v[164:167], a[248:251], a[184:187], v[164:167]
    ds_read_b64_tr_b16 a[242:243], v240 offset:43008
    v_add_f32 v252, v252, v212
    v_mfma_f32_16x16x32_bf16 v[172:175], a[248:251], a[208:211], v[172:175]
    s_add_u32 m0, s38, 0
    v_exp_f32 v154, v154
    v_mfma_f32_16x16x32_bf16 v[172:175], a[252:255], a[212:215], v[172:175]
    ds_read_b64_tr_b16 a[244:245], v241 offset:36864
    v_add_f32 v252, v252, v213
    v_mfma_f32_16x16x32_bf16 v[164:167], a[252:255], a[188:191], v[164:167]
    ds_read_b64_tr_b16 a[246:247], v241 offset:43008
    v_add_f32 v252, v252, v214
    v_mfma_f32_16x16x32_bf16 v[156:159], a[252:255], a[164:167], v[156:159]
    s_waitcnt lgkmcnt(4)
    s_cbranch_vccnz L_e_exit2
L_e_p4:
    v_add_f32 v252, v252, v215
    v_mfma_f32_16x16x32_bf16 v[0:3], a[232:235], v[184:187], v[0:3]
    ds_read_b64_tr_b16 a[248:249], v238 offset:36992
    v_add_f32 v232, v232, v152
    v_mfma_f32_16x16x32_bf16 v[48:51], a[232:235], v[192:195], v[48:51]
    ds_read_b64_tr_b16 a[250:251], v238 offset:43136
    v_add_f32 v232, v232, v153
    v_mfma_f32_16x16x32_bf16 v[96:99], a[232:235], v[200:203], v[96:99]
    buffer_load_dwordx4 v246, s[84:87], s36 offen offset:1024 nt lds
    v_mfma_f32_16x16x32_bf16 a[0:3], a[232:235], v[208:211], a[0:3]
    s_add_u32 m0, s38, 0
    v_exp_f32 v155, v155
    v_mfma_f32_16x16x32_bf16 a[4:7], a[236:239], v[208:211], a[4:7]
    ds_read_b64_tr_b16 a[252:253], v239 offset:36992
    v_cvt_pk_bf16_f32 v152, v152, v153
    v_mfma_f32_16x16x32_bf16 v[100:103], a[236:239], v[200:203], v[100:103]
    ds_read_b64_tr_b16 a[254:255], v239 offset:43136
    v_add_f32 v232, v232, v154
    v_mfma_f32_16x16x32_bf16 v[52:55], a[236:239], v[192:195], v[52:55]
    buffer_load_dwordx4 v253, s[84:87], s36 offen offset:2048 nt lds
    v_mfma_f32_16x16x32_bf16 v[4:7], a[236:239], v[184:187], v[4:7]
    s_waitcnt lgkmcnt(4)
    v_exp_f32 v160, v160
    v_mfma_f32_16x16x32_bf16 v[8:11], a[240:243], v[184:187], v[8:11]
    ds_read_b64_tr_b16 a[232:233], v240 offset:36992
    v_add_f32 v232, v232, v155
    v_mfma_f32_16x16x32_bf16 v[56:59], a[240:243], v[192:195], v[56:59]
    ds_read_b64_tr_b16 a[234:235], v240 offset:43136
    v_cvt_pk_bf16_f32 v153, v154, v155
    v_mfma_f32_16x16x32_bf16 v[104:107], a[240:243], v[200:203], v[104:107]
    s_add_u32 m0, s38, 12288
    v_exp_f32 v161, v161
    v_mfma_f32_16x16x32_bf16 a[8:11], a[240:243], v[208:211], a[8:11]
    buffer_load_dwordx4 v242, s[84:87], s37 offen offset:0 nt lds
    v_mfma_f32_16x16x32_bf16 a[12:15], a[244:247], v[208:211], a[12:15]
    ds_read_b64_tr_b16 a[236:237], v241 offset:36992
    v_add_f32 v233, v233, v160
    v_mfma_f32_16x16x32_bf16 v[108:111], a[244:247], v[200:203], v[108:111]
    ds_read_b64_tr_b16 a[238:239], v241 offset:43136
    v_add_f32 v233, v233, v161
    v_mfma_f32_16x16x32_bf16 v[60:63], a[244:247], v[192:195], v[60:63]
    s_add_u32 m0, s38, 12288
    v_exp_f32 v162, v162
    v_mfma_f32_16x16x32_bf16 v[12:15], a[244:247], v[184:187], v[12:15]
    s_waitcnt lgkmcnt(4)
    v_exp_f32 v163, v163
    v_mfma_f32_16x16x32_bf16 v[16:19], a[248:251], v[184:187], v[16:19]
    ds_read_b64_tr_b16 a[240:241], v238 offset:37120
    v_cvt_pk_bf16_f32 v160, v160, v161
    v_mfma_f32_16x16x32_bf16 v[64:67], a[248:251], v[192:195], v[64:67]
    ds_read_b64_tr_b16 a[242:243], v238 offset:43264
    v_add_f32 v233, v233, v162
    v_mfma_f32_16x16x32_bf16 v[112:115], a[248:251], v[200:203], v[112:115]
    buffer_load_dwordx4 v246, s[84:87], s37 offen offset:1024 nt lds
    v_mfma_f32_16x16x32_bf16 a[16:19], a[248:251], v[208:211], a[16:19]
    s_add_u32 m0, s38, 12288
    v_exp_f32 v168, v168
    v_mfma_f32_16x16x32_bf16 a[20:23], a[252:255], v[208:211], a[20:23]
    ds_read_b64_tr_b16 a[244:245], v239 offset:37120
    v_add_f32 v233, v233, v163
    v_mfma_f32_16x16x32_bf16 v[116:119], a[252:255], v[200:203], v[116:119]
    ds_read_b64_tr_b16 a[246:247], v239 offset:43264
    v_cvt_pk_bf16_f32 v161, v162, v163
    v_mfma_f32_16x16x32_bf16 v[68:71], a[252:255], v[192:195], v[68:71]
    buffer_load_dwordx4 v253, s[84:87], s37 offen offset:2048 nt lds
    v_mfma_f32_16x16x32_bf16 v[20:23], a[252:255], v[184:187], v[20:23]
    s_waitcnt lgkmcnt(4)
    v_exp_f32 v169, v169
    v_mfma_f32_16x16x32_bf16 v[24:27], a[232:235], v[184:187], v[24:27]
    ds_read_b64_tr_b16 a[248:249], v240 offset:37120
    v_add_f32 v234, v234, v168
    v_mfma_f32_16x16x32_bf16 v[72:75], a[232:235], v[192:195], v[72:75]
    ds_read_b64_tr_b16 a[250:251], v240 offset:43264
    v_add_f32 v234, v234, v169
    v_mfma_f32_16x16x32_bf16 v[120:123], a[232:235], v[200:203], v[120:123]
    s_add_u32 s36, s36, 24576
    v_exp_f32 v170, v170
    v_mfma_f32_16x16x32_bf16 a[24:27], a[232:235], v[208:211], a[24:27]
    s_add_u32 s37, s37, 24576
    v_exp_f32 v171, v171
    v_mfma_f32_16x16x32_bf16 a[28:31], a[236:239], v[208:211], a[28:31]
    ds_read_b64_tr_b16 a[252:253], v241 offset:37120
    v_cvt_pk_bf16_f32 v168, v168, v169
    v_mfma_f32_16x16x32_bf16 v[124:127], a[236:239], v[200:203], v[124:127]
    ds_read_b64_tr_b16 a[254:255], v241 offset:43264
    v_add_f32 v234, v234, v170
    v_mfma_f32_16x16x32_bf16 v[76:79], a[236:239], v[192:195], v[76:79]
    s_add_u32 s38, s31, s71
    v_exp_f32 v156, v156
    v_mfma_f32_16x16x32_bf16 v[28:31], a[236:239], v[184:187], v[28:31]
    s_waitcnt lgkmcnt(4)
    v_exp_f32 v157, v157
    v_mfma_f32_16x16x32_bf16 v[32:35], a[240:243], v[184:187], v[32:35]
    v_exp_f32 v158, v158
    v_mfma_f32_16x16x32_bf16 v[80:83], a[240:243], v[192:195], v[80:83]
    v_exp_f32 v159, v159
    v_mfma_f32_16x16x32_bf16 v[128:131], a[240:243], v[200:203], v[128:131]
    v_exp_f32 v164, v164
    v_mfma_f32_16x16x32_bf16 a[32:35], a[240:243], v[208:211], a[32:35]
    v_exp_f32 v165, v165
    v_mfma_f32_16x16x32_bf16 a[36:39], a[244:247], v[208:211], a[36:39]
    v_exp_f32 v166, v166
    v_mfma_f32_16x16x32_bf16 v[132:135], a[244:247], v[200:203], v[132:135]
    v_exp_f32 v167, v167
    v_mfma_f32_16x16x32_bf16 v[84:87], a[244:247], v[192:195], v[84:87]
    s_waitcnt vmcnt(12) lgkmcnt(0)
    v_add_u32 v238, s41, v238
    v_add_u32 v239, s41, v239
    v_mfma_f32_16x16x32_bf16 v[36:39], a[244:247], v[184:187], v[36:39]
    s_barrier
    v_mfma_f32_16x16x32_bf16 v[40:43], a[248:251], v[184:187], v[40:43]
    ds_read_b128 a[232:235], v236 offset:0
    v_mfma_f32_16x16x32_bf16 v[88:91], a[248:251], v[192:195], v[88:91]
    ds_read_b128 a[236:239], v237 offset:0
    v_mfma_f32_16x16x32_bf16 v[136:139], a[248:251], v[200:203], v[136:139]
    v_mfma_f32_16x16x32_bf16 a[40:43], a[248:251], v[208:211], a[40:43]
    v_mfma_f32_16x16x32_bf16 a[44:47], a[252:255], v[208:211], a[44:47]
    s_setpc_b64 s[62:63]
    .p2align 6
L_o_body:
    s_waitcnt lgkmcnt(0)
    v_mfma_f32_16x16x32_bf16 v[184:187], a[232:235], a[144:147], v[216:219]
    ds_read_b128 a[240:243], v236 offset:128
    v_mfma_f32_16x16x32_bf16 v[192:195], a[232:235], a[168:171], v[220:223]
    ds_read_b128 a[244:247], v237 offset:128
    v_mfma_f32_16x16x32_bf16 v[200:203], a[232:235], a[192:195], v[224:227]
    ds_read_b128 a[248:251], v236 offset:256
    v_mfma_f32_16x16x32_bf16 v[200:203], a[236:239], a[196:199], v[200:203]
    ds_read_b128 a[252:255], v237 offset:256
    v_mfma_f32_16x16x32_bf16 v[192:195], a[236:239], a[172:175], v[192:195]
    v_exp_f32 v166, v166
    v_mfma_f32_16x16x32_bf16 v[184:187], a[236:239], a[148:151], v[184:187]
    s_waitcnt lgkmcnt(3)
    v_exp_f32 v167, v167
    v_mfma_f32_16x16x32_bf16 v[184:187], a[240:243], a[152:155], v[184:187]
    ds_read_b128 a[232:235], v236 offset:6144
    v_add_u32 v238, s41, v238
    v_mfma_f32_16x16x32_bf16 v[192:195], a[240:243], a[176:179], v[192:195]
    v_exp_f32 v172, v172
    v_mfma_f32_16x16x32_bf16 v[200:203], a[240:243], a[200:203], v[200:203]
    s_waitcnt lgkmcnt(3)
    v_exp_f32 v173, v173
    v_mfma_f32_16x16x32_bf16 v[200:203], a[244:247], a[204:207], v[200:203]
    ds_read_b128 a[236:239], v237 offset:6144
    v_add_u32 v239, s41, v239
    v_mfma_f32_16x16x32_bf16 v[192:195], a[244:247], a[180:183], v[192:195]
    v_add_u32 v240, s41, v240
    v_add_u32 v241, s41, v241
    v_mfma_f32_16x16x32_bf16 v[184:187], a[244:247], a[156:159], v[184:187]
    s_waitcnt lgkmcnt(2)
    v_cvt_pk_bf16_f32 v177, v178, v179
    v_mfma_f32_16x16x32_bf16 v[184:187], a[248:251], a[160:163], v[184:187]
    ds_read_b128 a[240:243], v236 offset:6272
    v_cvt_pk_bf16_f32 v154, v156, v157
    v_mfma_f32_16x16x32_bf16 v[192:195], a[248:251], a[184:187], v[192:195]
    v_exp_f32 v174, v174
    v_mfma_f32_16x16x32_bf16 v[200:203], a[248:251], a[208:211], v[200:203]
    v_exp_f32 v175, v175
    v_mfma_f32_16x16x32_bf16 v[200:203], a[252:255], a[212:215], v[200:203]
    ds_read_b128 a[244:247], v237 offset:6272
    v_cvt_pk_bf16_f32 v155, v158, v159
    v_mfma_f32_16x16x32_bf16 v[192:195], a[252:255], a[188:191], v[192:195]
    v_exp_f32 v180, v180
    v_mfma_f32_16x16x32_bf16 v[184:187], a[252:255], a[164:167], v[184:187]
    s_waitcnt lgkmcnt(2)
    v_exp_f32 v181, v181
    v_mfma_f32_16x16x32_bf16 v[188:191], a[232:235], a[144:147], v[216:219]
    ds_read_b128 a[248:251], v236 offset:6400
    v_cvt_pk_bf16_f32 v162, v164, v165
    v_mfma_f32_16x16x32_bf16 v[196:199], a[232:235], a[168:171], v[220:223]
    v_exp_f32 v182, v182
    v_mfma_f32_16x16x32_bf16 v[204:207], a[232:235], a[192:195], v[224:227]
    v_exp_f32 v183, v183
    v_mfma_f32_16x16x32_bf16 v[204:207], a[236:239], a[196:199], v[204:207]
    ds_read_b128 a[252:255], v237 offset:6400
    v_cvt_pk_bf16_f32 v163, v166, v167
    v_mfma_f32_16x16x32_bf16 v[196:199], a[236:239], a[172:175], v[196:199]
    v_cvt_pk_bf16_f32 v170, v172, v173
    v_mfma_f32_16x16x32_bf16 v[188:191], a[236:239], a[148:151], v[188:191]
    s_waitcnt lgkmcnt(2)
    v_cvt_pk_bf16_f32 v171, v174, v175
    v_mfma_f32_16x16x32_bf16 v[188:191], a[240:243], a[152:155], v[188:191]
    ds_read_b64_tr_b16 a[232:233], v238 offset:24576
    v_cvt_pk_bf16_f32 v178, v180, v181
    v_mfma_f32_16x16x32_bf16 v[196:199], a[240:243], a[176:179], v[196:199]
    ds_read_b64_tr_b16 a[234:235], v238 offset:30720
    v_cvt_pk_bf16_f32 v179, v182, v183
    v_mfma_f32_16x16x32_bf16 v[204:207], a[240:243], a[200:203], v[204:207]
    v_exp_f32 v184, v184
    v_mfma_f32_16x16x32_bf16 v[204:207], a[244:247], a[204:207], v[204:207]
    ds_read_b64_tr_b16 a[236:237], v239 offset:24576
    v_add_f32 v232, v232, v156
    v_mfma_f32_16x16x32_bf16 v[196:199], a[244:247], a[180:183], v[196:199]
    ds_read_b64_tr_b16 a[238:239], v239 offset:30720
    v_add_f32 v232, v232, v157
    v_mfma_f32_16x16x32_bf16 v[188:191], a[244:247], a[156:159], v[188:191]
    s_waitcnt lgkmcnt(4)
    v_exp_f32 v185, v185
    v_mfma_f32_16x16x32_bf16 v[188:191], a[248:251], a[160:163], v[188:191]
    ds_read_b64_tr_b16 a[240:241], v240 offset:24576
    v_add_f32 v232, v232, v158
    v_mfma_f32_16x16x32_bf16 v[196:199], a[248:251], a[184:187], v[196:199]
    ds_read_b64_tr_b16 a[242:243], v240 offset:30720
    v_add_f32 v232, v232, v159
    v_mfma_f32_16x16x32_bf16 v[204:207], a[248:251], a[208:211], v[204:207]
    v_exp_f32 v186, v186
    v_mfma_f32_16x16x32_bf16 v[204:207], a[252:255], a[212:215], v[204:207]
    ds_read_b64_tr_b16 a[244:245], v241 offset:24576
    v_add_f32 v233, v233, v164
    v_mfma_f32_16x16x32_bf16 v[196:199], a[252:255], a[188:191], v[196:199]
    ds_read_b64_tr_b16 a[246:247], v241 offset:30720
    v_add_f32 v233, v233, v165
    v_mfma_f32_16x16x32_bf16 v[188:191], a[252:255], a[164:167], v[188:191]
    s_waitcnt lgkmcnt(4)
    v_exp_f32 v187, v187
L_o_p2:
    v_mfma_f32_16x16x32_bf16 v[0:3], a[232:235], v[152:155], v[0:3]
    ds_read_b64_tr_b16 a[248:249], v238 offset:24704
    v_add_f32 v233, v233, v166
    v_mfma_f32_16x16x32_bf16 v[48:51], a[232:235], v[160:163], v[48:51]
    ds_read_b64_tr_b16 a[250:251], v238 offset:30848
    v_add_f32 v233, v233, v167
    v_mfma_f32_16x16x32_bf16 v[96:99], a[232:235], v[168:171], v[96:99]
    s_add_u32 m0, s40, 0
    v_add_f32 v234, v234, v172
    v_add_f32 v234, v234, v173
    v_mfma_f32_16x16x32_bf16 a[24:27], a[232:235], v[176:179], a[24:27]
    buffer_load_dwordx4 v242, s[72:75], s36 offen offset:0 nt lds
    v_mfma_f32_16x16x32_bf16 a[28:31], a[236:239], v[176:179], a[28:31]
    ds_read_b64_tr_b16 a[252:253], v239 offset:24704
    v_add_f32 v234, v234, v174
    v_mfma_f32_16x16x32_bf16 v[100:103], a[236:239], v[168:171], v[100:103]
    ds_read_b64_tr_b16 a[254:255], v239 offset:30848
    v_add_f32 v234, v234, v175
    v_mfma_f32_16x16x32_bf16 v[52:55], a[236:239], v[160:163], v[52:55]
    v_add_f32 v235, v235, v180
    v_add_f32 v235, v235, v181
    v_mfma_f32_16x16x32_bf16 v[4:7], a[236:239], v[152:155], v[4:7]
    s_waitcnt lgkmcnt(4)
    v_add_f32 v235, v235, v182
    v_add_f32 v235, v235, v183
    v_mfma_f32_16x16x32_bf16 v[8:11], a[240:243], v[152:155], v[8:11]
    ds_read_b64_tr_b16 a[232:233], v240 offset:24704
    v_add_f32 v249, v249, v184
    v_mfma_f32_16x16x32_bf16 v[56:59], a[240:243], v[160:163], v[56:59]
    ds_read_b64_tr_b16 a[234:235], v240 offset:30848
    v_add_f32 v249, v249, v185
    v_mfma_f32_16x16x32_bf16 v[104:107], a[240:243], v[168:171], v[104:107]
    s_add_u32 m0, s40, 0
    v_exp_f32 v192, v192
    v_mfma_f32_16x16x32_bf16 a[32:35], a[240:243], v[176:179], a[32:35]
    buffer_load_dwordx4 v246, s[72:75], s36 offen offset:1024 nt lds
    v_mfma_f32_16x16x32_bf16 a[36:39], a[244:247], v[176:179], a[36:39]
    ds_read_b64_tr_b16 a[236:237], v241 offset:24704
    v_cvt_pk_bf16_f32 v184, v184, v185
    v_mfma_f32_16x16x32_bf16 v[108:111], a[244:247], v[168:171], v[108:111]
    ds_read_b64_tr_b16 a[238:239], v241 offset:30848
    v_add_f32 v249, v249, v186
    v_mfma_f32_16x16x32_bf16 v[60:63], a[244:247], v[160:163], v[60:63]
    v_exp_f32 v193, v193
    v_mfma_f32_16x16x32_bf16 v[12:15], a[244:247], v[152:155], v[12:15]
    s_waitcnt lgkmcnt(4)
    v_exp_f32 v194, v194
    v_mfma_f32_16x16x32_bf16 v[16:19], a[248:251], v[152:155], v[16:19]
    ds_read_b64_tr_b16 a[240:241], v238 offset:24832
    v_add_f32 v249, v249, v187
    v_mfma_f32_16x16x32_bf16 v[64:67], a[248:251], v[160:163], v[64:67]
    ds_read_b64_tr_b16 a[242:243], v238 offset:30976
    v_cvt_pk_bf16_f32 v185, v186, v187
    v_mfma_f32_16x16x32_bf16 v[112:115], a[248:251], v[168:171], v[112:115]
    s_add_u32 m0, s40, 0
    v_exp_f32 v195, v195
    v_mfma_f32_16x16x32_bf16 a[40:43], a[248:251], v[176:179], a[40:43]
    buffer_load_dwordx4 v253, s[72:75], s36 offen offset:2048 nt lds
    v_mfma_f32_16x16x32_bf16 a[44:47], a[252:255], v[176:179], a[44:47]
    ds_read_b64_tr_b16 a[244:245], v239 offset:24832
    v_add_f32 v250, v250, v192
    v_mfma_f32_16x16x32_bf16 v[116:119], a[252:255], v[168:171], v[116:119]
    ds_read_b64_tr_b16 a[246:247], v239 offset:30976
    v_add_f32 v250, v250, v193
    v_mfma_f32_16x16x32_bf16 v[68:71], a[252:255], v[160:163], v[68:71]
    v_exp_f32 v200, v200
    v_mfma_f32_16x16x32_bf16 v[20:23], a[252:255], v[152:155], v[20:23]
    s_waitcnt lgkmcnt(4)
    v_exp_f32 v201, v201
    v_mfma_f32_16x16x32_bf16 v[24:27], a[232:235], v[152:155], v[24:27]
    ds_read_b64_tr_b16 a[248:249], v240 offset:24832
    v_cvt_pk_bf16_f32 v192, v192, v193
    v_mfma_f32_16x16x32_bf16 v[72:75], a[232:235], v[160:163], v[72:75]
    ds_read_b64_tr_b16 a[250:251], v240 offset:30976
    v_add_f32 v250, v250, v194
    v_mfma_f32_16x16x32_bf16 v[120:123], a[232:235], v[168:171], v[120:123]
    v_exp_f32 v202, v202
    v_mfma_f32_16x16x32_bf16 a[0:3], a[232:235], v[176:179], a[0:3]
    s_add_u32 m0, s40, 12288
    v_add_f32 v250, v250, v195
    v_mfma_f32_16x16x32_bf16 a[4:7], a[236:239], v[176:179], a[4:7]
    ds_read_b64_tr_b16 a[252:253], v241 offset:24832
    v_cvt_pk_bf16_f32 v193, v194, v195
    v_mfma_f32_16x16x32_bf16 v[124:127], a[236:239], v[168:171], v[124:127]
    ds_read_b64_tr_b16 a[254:255], v241 offset:30976
    v_add_f32 v251, v251, v200
    v_mfma_f32_16x16x32_bf16 v[76:79], a[236:239], v[160:163], v[76:79]
    buffer_load_dwordx4 v242, s[72:75], s37 offen offset:0 nt lds
    v_mfma_f32_16x16x32_bf16 v[28:31], a[236:239], v[152:155], v[28:31]
    s_waitcnt lgkmcnt(4)
    v_exp_f32 v203, v203
    v_mfma_f32_16x16x32_bf16 v[32:35], a[240:243], v[152:155], v[32:35]
    ds_read_b128 a[232:235], v236 offset:12288
    v_add_f32 v251, v251, v201
    v_mfma_f32_16x16x32_bf16 v[80:83], a[240:243], v[160:163], v[80:83]
    v_exp_f32 v188, v188
    v_mfma_f32_16x16x32_bf16 v[128:131], a[240:243], v[168:171], v[128:131]
    s_add_u32 m0, s40, 12288
    v_exp_f32 v189, v189
    v_mfma_f32_16x16x32_bf16 a[8:11], a[240:243], v[176:179], a[8:11]
    buffer_load_dwordx4 v246, s[72:75], s37 offen offset:1024 nt lds
    v_mfma_f32_16x16x32_bf16 a[12:15], a[244:247], v[176:179], a[12:15]
    ds_read_b128 a[236:239], v237 offset:12288
    v_cvt_pk_bf16_f32 v200, v200, v201
    v_mfma_f32_16x16x32_bf16 v[132:135], a[244:247], v[168:171], v[132:135]
    v_exp_f32 v190, v190
    v_mfma_f32_16x16x32_bf16 v[84:87], a[244:247], v[160:163], v[84:87]
    s_add_u32 m0, s40, 12288
    v_exp_f32 v191, v191
    v_mfma_f32_16x16x32_bf16 v[36:39], a[244:247], v[152:155], v[36:39]
    s_waitcnt lgkmcnt(2)
    v_exp_f32 v196, v196
    v_mfma_f32_16x16x32_bf16 v[40:43], a[248:251], v[152:155], v[40:43]
    ds_read_b128 a[240:243], v236 offset:12416
    v_add_f32 v251, v251, v202
    v_mfma_f32_16x16x32_bf16 v[88:91], a[248:251], v[160:163], v[88:91]
    buffer_load_dwordx4 v253, s[72:75], s37 offen offset:2048 nt lds
    v_mfma_f32_16x16x32_bf16 v[136:139], a[248:251], v[168:171], v[136:139]
    v_exp_f32 v197, v197
    v_mfma_f32_16x16x32_bf16 a[16:19], a[248:251], v[176:179], a[16:19]
    v_exp_f32 v198, v198
    v_mfma_f32_16x16x32_bf16 a[20:23], a[252:255], v[176:179], a[20:23]
    ds_read_b128 a[244:247], v237 offset:12416
    v_add_f32 v251, v251, v203
    v_mfma_f32_16x16x32_bf16 v[140:143], a[252:255], v[168:171], v[140:143]
    s_add_u32 m0, s38, 0
    v_exp_f32 v199, v199
    v_mfma_f32_16x16x32_bf16 v[92:95], a[252:255], v[160:163], v[92:95]
    s_waitcnt lgkmcnt(2)
    v_exp_f32 v204, v204
    v_mfma_f32_16x16x32_bf16 v[44:47], a[252:255], v[152:155], v[44:47]
    s_cbranch_vccnz L_o_exit
L_o_mid:
    v_exp_f32 v205, v205
    v_mfma_f32_16x16x32_bf16 v[152:155], a[232:235], a[144:147], v[216:219]
    ds_read_b128 a[248:251], v236 offset:12544
    v_cvt_pk_bf16_f32 v201, v202, v203
    v_mfma_f32_16x16x32_bf16 v[160:163], a[232:235], a[168:171], v[220:223]
    buffer_load_dwordx4 v242, s[84:87], s36 offen offset:0 nt lds
    v_mfma_f32_16x16x32_bf16 v[168:171], a[232:235], a[192:195], v[224:227]
    s_sub_u32 s41, s42, s39
    v_exp_f32 v206, v206
    v_mfma_f32_16x16x32_bf16 v[176:179], a[232:235], a[216:219], v[228:231]
    s_add_u32 m0, s38, 0
    v_exp_f32 v207, v207
    v_mfma_f32_16x16x32_bf16 v[176:179], a[236:239], a[220:223], v[176:179]
    ds_read_b128 a[252:255], v237 offset:12544
    v_cvt_pk_bf16_f32 v186, v188, v189
    v_mfma_f32_16x16x32_bf16 v[168:171], a[236:239], a[196:199], v[168:171]
    buffer_load_dwordx4 v246, s[84:87], s36 offen offset:1024 nt lds
    v_mfma_f32_16x16x32_bf16 v[160:163], a[236:239], a[172:175], v[160:163]
    s_mov_b32 s59, s39
    v_cvt_pk_bf16_f32 v187, v190, v191
    v_mfma_f32_16x16x32_bf16 v[152:155], a[236:239], a[148:151], v[152:155]
    s_waitcnt lgkmcnt(2)
    v_cvt_pk_bf16_f32 v194, v196, v197
    v_mfma_f32_16x16x32_bf16 v[152:155], a[240:243], a[152:155], v[152:155]
    ds_read_b128 a[232:235], v236 offset:18432
    v_cvt_pk_bf16_f32 v195, v198, v199
    v_mfma_f32_16x16x32_bf16 v[160:163], a[240:243], a[176:179], v[160:163]
    s_add_u32 m0, s38, 0
    v_cvt_pk_bf16_f32 v202, v204, v205
    v_mfma_f32_16x16x32_bf16 v[168:171], a[240:243], a[200:203], v[168:171]
    buffer_load_dwordx4 v253, s[84:87], s36 offen offset:2048 nt lds
    v_mfma_f32_16x16x32_bf16 v[176:179], a[240:243], a[224:227], v[176:179]
    s_mov_b32 s39, s42
    v_cvt_pk_bf16_f32 v203, v206, v207
    v_mfma_f32_16x16x32_bf16 v[176:179], a[244:247], a[228:231], v[176:179]
    ds_read_b128 a[236:239], v237 offset:18432
    v_add_f32 v249, v249, v188
    v_mfma_f32_16x16x32_bf16 v[168:171], a[244:247], a[204:207], v[168:171]
    s_mov_b32 s42, s31
    v_add_f32 v249, v249, v189
    v_mfma_f32_16x16x32_bf16 v[160:163], a[244:247], a[180:183], v[160:163]
    s_add_u32 m0, s38, 12288
    v_add_f32 v249, v249, v190
    v_mfma_f32_16x16x32_bf16 v[152:155], a[244:247], a[156:159], v[152:155]
    s_waitcnt lgkmcnt(2)
    v_add_f32 v249, v249, v191
    v_mfma_f32_16x16x32_bf16 v[152:155], a[248:251], a[160:163], v[152:155]
    ds_read_b128 a[240:243], v236 offset:18560
    v_add_f32 v250, v250, v196
    v_mfma_f32_16x16x32_bf16 v[160:163], a[248:251], a[184:187], v[160:163]
    buffer_load_dwordx4 v242, s[84:87], s37 offen offset:0 nt lds
    v_mfma_f32_16x16x32_bf16 v[168:171], a[248:251], a[208:211], v[168:171]
    s_mov_b32 s31, s59
    v_add_f32 v250, v250, v197
    v_mfma_f32_16x16x32_bf16 v[176:179], a[248:251], v[144:147], v[176:179]
    s_add_u32 m0, s38, 12288
    v_add_f32 v250, v250, v198
    v_mfma_f32_16x16x32_bf16 v[176:179], a[252:255], v[148:151], v[176:179]
    ds_read_b128 a[244:247], v237 offset:18560
    v_add_f32 v250, v250, v199
    v_mfma_f32_16x16x32_bf16 v[168:171], a[252:255], a[212:215], v[168:171]
    buffer_load_dwordx4 v246, s[84:87], s37 offen offset:1024 nt lds
    v_mfma_f32_16x16x32_bf16 v[160:163], a[252:255], a[188:191], v[160:163]
    s_add_u32 s36, s36, 24576
    v_add_f32 v251, v251, v204
    v_mfma_f32_16x16x32_bf16 v[152:155], a[252:255], a[164:167], v[152:155]
    s_waitcnt lgkmcnt(2)
    v_add_f32 v251, v251, v205
    v_mfma_f32_16x16x32_bf16 v[156:159], a[232:235], a[144:147], v[216:219]
    ds_read_b128 a[248:251], v236 offset:18688
    v_add_f32 v251, v251, v206
    v_mfma_f32_16x16x32_bf16 v[164:167], a[232:235], a[168:171], v[220:223]
    s_add_u32 m0, s38, 12288
    v_add_f32 v251, v251, v207
    v_mfma_f32_16x16x32_bf16 v[172:175], a[232:235], a[192:195], v[224:227]
    buffer_load_dwordx4 v253, s[84:87], s37 offen offset:2048 nt lds
    v_mfma_f32_16x16x32_bf16 v[180:183], a[232:235], a[216:219], v[228:231]
    s_add_u32 s40, s31, s70
    v_mfma_f32_16x16x32_bf16 v[180:183], a[236:239], a[220:223], v[180:183]
    ds_read_b128 a[252:255], v237 offset:18688
    v_mfma_f32_16x16x32_bf16 v[172:175], a[236:239], a[196:199], v[172:175]
    s_add_u32 s37, s37, 24576
    v_add_u32 v236, s41, v236
    v_mfma_f32_16x16x32_bf16 v[164:167], a[236:239], a[172:175], v[164:167]
    s_add_u32 s38, s31, s71
    v_add_u32 v237, s41, v237
    v_mfma_f32_16x16x32_bf16 v[156:159], a[236:239], a[148:151], v[156:159]
    s_waitcnt lgkmcnt(2)
    v_exp_f32 v152, v152
    v_mfma_f32_16x16x32_bf16 v[156:159], a[240:243], a[152:155], v[156:159]
    ds_read_b64_tr_b16 a[232:233], v238 offset:36864
    v_add_f32 v232, v232, v152
    v_mfma_f32_16x16x32_bf16 v[164:167], a[240:243], a[176:179], v[164:167]
    ds_read_b64_tr_b16 a[234:235], v238 offset:43008
    v_mfma_f32_16x16x32_bf16 v[172:175], a[240:243], a[200:203], v[172:175]
    v_exp_f32 v153, v153
    v_mfma_f32_16x16x32_bf16 v[180:183], a[240:243], a[224:227], v[180:183]
    v_exp_f32 v154, v154
    v_mfma_f32_16x16x32_bf16 v[180:183], a[244:247], a[228:231], v[180:183]
    ds_read_b64_tr_b16 a[236:237], v239 offset:36864
    v_add_f32 v232, v232, v153
    v_mfma_f32_16x16x32_bf16 v[172:175], a[244:247], a[204:207], v[172:175]
    ds_read_b64_tr_b16 a[238:239], v239 offset:43008
    v_cvt_pk_bf16_f32 v152, v152, v153
    v_mfma_f32_16x16x32_bf16 v[164:167], a[244:247], a[180:183], v[164:167]
    v_exp_f32 v155, v155
    v_mfma_f32_16x16x32_bf16 v[156:159], a[244:247], a[156:159], v[156:159]
    s_waitcnt lgkmcnt(4)
    v_exp_f32 v160, v160
    v_mfma_f32_16x16x32_bf16 v[156:159], a[248:251], a[160:163], v[156:159]
    ds_read_b64_tr_b16 a[240:241], v240 offset:36864
    v_add_f32 v232, v232, v154
    v_mfma_f32_16x16x32_bf16 v[164:167], a[248:251], a[184:187], v[164:167]
    ds_read_b64_tr_b16 a[242:243], v240 offset:43008
    v_add_f32 v232, v232, v155
    v_mfma_f32_16x16x32_bf16 v[172:175], a[248:251], a[208:211], v[172:175]
    v_exp_f32 v161, v161
    v_mfma_f32_16x16x32_bf16 v[180:183], a[248:251], v[144:147], v[180:183]
    v_exp_f32 v162, v162
    v_mfma_f32_16x16x32_bf16 v[180:183], a[252:255], v[148:151], v[180:183]
    ds_read_b64_tr_b16 a[244:245], v241 offset:36864
    v_cvt_pk_bf16_f32 v153, v154, v155
    v_mfma_f32_16x16x32_bf16 v[172:175], a[252:255], a[212:215], v[172:175]
    ds_read_b64_tr_b16 a[246:247], v241 offset:43008
    v_add_f32 v233, v233, v160
    v_mfma_f32_16x16x32_bf16 v[164:167], a[252:255], a[188:191], v[164:167]
    v_exp_f32 v163, v163
    v_mfma_f32_16x16x32_bf16 v[156:159], a[252:255], a[164:167], v[156:159]
    s_waitcnt lgkmcnt(4)
    v_exp_f32 v168, v168
    v_mfma_f32_16x16x32_bf16 v[0:3], a[232:235], v[184:187], v[0:3]
    ds_read_b64_tr_b16 a[248:249], v238 offset:36992
    v_add_f32 v233, v233, v161
    v_mfma_f32_16x16x32_bf16 v[48:51], a[232:235], v[192:195], v[48:51]
    ds_read_b64_tr_b16 a[250:251], v238 offset:43136
    v_cvt_pk_bf16_f32 v160, v160, v161
    v_mfma_f32_16x16x32_bf16 v[96:99], a[232:235], v[200:203], v[96:99]
    v_exp_f32 v169, v169
    v_mfma_f32_16x16x32_bf16 v[100:103], a[236:239], v[200:203], v[100:103]
    ds_read_b64_tr_b16 a[252:253], v239 offset:36992
    v_add_f32 v233, v233, v162
    v_mfma_f32_16x16x32_bf16 v[52:55], a[236:239], v[192:195], v[52:55]
    ds_read_b64_tr_b16 a[254:255], v239 offset:43136
    v_add_f32 v233, v233, v163
    v_mfma_f32_16x16x32_bf16 v[4:7], a[236:239], v[184:187], v[4:7]
    s_waitcnt lgkmcnt(4)
    v_exp_f32 v170, v170
    v_mfma_f32_16x16x32_bf16 v[8:11], a[240:243], v[184:187], v[8:11]
    ds_read_b64_tr_b16 a[232:233], v240 offset:36992
    v_cvt_pk_bf16_f32 v161, v162, v163
    v_mfma_f32_16x16x32_bf16 v[56:59], a[240:243], v[192:195], v[56:59]
    ds_read_b64_tr_b16 a[234:235], v240 offset:43136
    v_add_f32 v234, v234, v168
    v_mfma_f32_16x16x32_bf16 v[104:107], a[240:243], v[200:203], v[104:107]
    v_exp_f32 v171, v171
    v_mfma_f32_16x16x32_bf16 v[108:111], a[244:247], v[200:203], v[108:111]
    ds_read_b64_tr_b16 a[236:237], v241 offset:36992
    v_add_f32 v234, v234, v169
    v_mfma_f32_16x16x32_bf16 v[60:63], a[244:247], v[192:195], v[60:63]
    ds_read_b64_tr_b16 a[238:239], v241 offset:43136
    v_cvt_pk_bf16_f32 v168, v168, v169
    v_mfma_f32_16x16x32_bf16 v[12:15], a[244:247], v[184:187], v[12:15]
    s_waitcnt lgkmcnt(4)
    v_exp_f32 v176, v176
    v_mfma_f32_16x16x32_bf16 v[16:19], a[248:251], v[184:187], v[16:19]
    ds_read_b64_tr_b16 a[240:241], v238 offset:37120
    v_add_f32 v234, v234, v170
    v_mfma_f32_16x16x32_bf16 v[64:67], a[248:251], v[192:195], v[64:67]
    ds_read_b64_tr_b16 a[242:243], v238 offset:43264
    v_add_f32 v234, v234, v171
    v_mfma_f32_16x16x32_bf16 v[112:115], a[248:251], v[200:203], v[112:115]
    v_exp_f32 v177, v177
    v_mfma_f32_16x16x32_bf16 v[116:119], a[252:255], v[200:203], v[116:119]
    ds_read_b64_tr_b16 a[244:245], v239 offset:37120
    v_cvt_pk_bf16_f32 v169, v170, v171
    v_mfma_f32_16x16x32_bf16 v[68:71], a[252:255], v[192:195], v[68:71]
    ds_read_b64_tr_b16 a[246:247], v239 offset:43264
    v_add_f32 v235, v235, v176
    v_mfma_f32_16x16x32_bf16 v[20:23], a[252:255], v[184:187], v[20:23]
    s_waitcnt lgkmcnt(4)
    v_exp_f32 v178, v178
    v_mfma_f32_16x16x32_bf16 v[24:27], a[232:235], v[184:187], v[24:27]
    ds_read_b64_tr_b16 a[248:249], v240 offset:37120
    v_add_f32 v235, v235, v177
    v_mfma_f32_16x16x32_bf16 v[72:75], a[232:235], v[192:195], v[72:75]
    ds_read_b64_tr_b16 a[250:251], v240 offset:43264
    v_cvt_pk_bf16_f32 v176, v176, v177
    v_mfma_f32_16x16x32_bf16 v[120:123], a[232:235], v[200:203], v[120:123]
    v_exp_f32 v179, v179
    v_mfma_f32_16x16x32_bf16 v[124:127], a[236:239], v[200:203], v[124:127]
    ds_read_b64_tr_b16 a[252:253], v241 offset:37120
    v_add_f32 v235, v235, v178
    v_mfma_f32_16x16x32_bf16 v[76:79], a[236:239], v[192:195], v[76:79]
    ds_read_b64_tr_b16 a[254:255], v241 offset:43264
    v_add_f32 v235, v235, v179
    v_mfma_f32_16x16x32_bf16 v[28:31], a[236:239], v[184:187], v[28:31]
    s_waitcnt lgkmcnt(4)
    v_exp_f32 v156, v156
    v_mfma_f32_16x16x32_bf16 v[32:35], a[240:243], v[184:187], v[32:35]
    v_exp_f32 v157, v157
    v_mfma_f32_16x16x32_bf16 v[80:83], a[240:243], v[192:195], v[80:83]
    v_exp_f32 v158, v158
    v_mfma_f32_16x16x32_bf16 v[128:131], a[240:243], v[200:203], v[128:131]
    v_exp_f32 v159, v159
    v_mfma_f32_16x16x32_bf16 v[132:135], a[244:247], v[200:203], v[132:135]
    v_exp_f32 v164, v164
    v_mfma_f32_16x16x32_bf16 v[84:87], a[244:247], v[192:195], v[84:87]
    s_waitcnt vmcnt(12) lgkmcnt(0)
    v_exp_f32 v165, v165
    v_mfma_f32_16x16x32_bf16 v[36:39], a[244:247], v[184:187], v[36:39]
    s_barrier
    v_mfma_f32_16x16x32_bf16 v[40:43], a[248:251], v[184:187], v[40:43]
    ds_read_b128 a[232:235], v236 offset:0
    v_mfma_f32_16x16x32_bf16 v[88:91], a[248:251], v[192:195], v[88:91]
    ds_read_b128 a[236:239], v237 offset:0
    v_mfma_f32_16x16x32_bf16 v[136:139], a[248:251], v[200:203], v[136:139]
    s_setpc_b64 s[62:63]
L_psx:
    ds_read_b128 a[248:251], v236 offset:12544
    ds_read_b128 a[252:255], v237 offset:12544
    v_add_f32 v249, v249, v232
    v_add_f32 v250, v250, v233
    v_add_f32 v251, v251, v234
    v_add_f32 v252, v252, v235
    s_waitcnt lgkmcnt(2)
    v_mfma_f32_16x16x32_bf16 v[216:219], a[232:235], a[48:51], 0
    s_nop 0
    s_nop 0
    v_mfma_f32_16x16x32_bf16 v[216:219], a[236:239], a[52:55], v[216:219]
    s_waitcnt lgkmcnt(0)
    v_bfe_u32 v176, v247, 2, 1
    v_mfma_f32_16x16x32_bf16 v[216:219], a[240:243], a[56:59], v[216:219]
    v_lshlrev_b32 v176, 4, v176
    v_mov_b32 v177, 0x3dd5
    v_lshlrev_b32 v168, v176, v177
    v_mfma_f32_16x16x32_bf16 v[216:219], a[244:247], a[60:63], v[216:219]
    v_mov_b32 v177, 0x38ee
    v_lshlrev_b32 v170, v176, v177
    v_mfma_f32_16x16x32_bf16 v[216:219], a[248:251], a[64:67], v[216:219]
    v_bfe_i32 v176, v247, 3, 1
    v_and_b32 v169, v176, v168
    v_mfma_f32_16x16x32_bf16 v[216:219], a[252:255], a[68:71], v[216:219]
    v_and_b32 v171, v176, v170
    v_xor_b32 v168, v168, v169
    v_xor_b32 v170, v170, v171
    s_nop 0
    v_mfma_f32_4x4x4_16b_bf16 v[152:155], v[168:169], a[48:49], 0
    v_mfma_f32_4x4x4_16b_bf16 v[156:159], v[168:169], a[50:51], 0
    s_nop 0
    v_mfma_f32_4x4x4_16b_bf16 v[152:155], v[170:171], a[48:49], v[152:155]
    v_mfma_f32_4x4x4_16b_bf16 v[160:163], v[168:169], a[52:53], 0
    v_mfma_f32_4x4x4_16b_bf16 v[156:159], v[170:171], a[50:51], v[156:159]
    v_max3_f32 v178, v216, v217, v218
    v_mfma_f32_4x4x4_16b_bf16 v[164:167], v[168:169], a[54:55], 0
    s_nop 0
    v_cvt_pk_bf16_f32 v172, v152, v153
    v_mfma_f32_4x4x4_16b_bf16 v[160:163], v[170:171], a[52:53], v[160:163]
    v_cvt_pk_bf16_f32 v173, v154, v155
    v_max_f32 v178, v178, v219
    v_mfma_f32_4x4x4_16b_bf16 v[152:155], v[168:169], a[56:57], 0
    v_cvt_pk_bf16_f32 v174, v156, v157
    v_mfma_f32_4x4x4_16b_bf16 v[164:167], v[170:171], a[54:55], v[164:167]
    v_cvt_pk_bf16_f32 v175, v158, v159
    v_accvgpr_write_b32 a144, v172
    v_accvgpr_write_b32 a145, v173
    v_mov_b32 v179, v178
    v_mfma_f32_4x4x4_16b_bf16 v[156:159], v[168:169], a[58:59], 0
    v_cvt_pk_bf16_f32 v172, v160, v161
    v_mfma_f32_4x4x4_16b_bf16 v[152:155], v[170:171], a[56:57], v[152:155]
    v_cvt_pk_bf16_f32 v173, v162, v163
    v_accvgpr_write_b32 a146, v174
    v_accvgpr_write_b32 a147, v175
    v_permlane32_swap_b32 v178, v179
    v_max_f32 v178, v178, v179
    s_nop 0
    v_mfma_f32_4x4x4_16b_bf16 v[160:163], v[168:169], a[60:61], 0
    v_cvt_pk_bf16_f32 v174, v164, v165
    v_mfma_f32_4x4x4_16b_bf16 v[156:159], v[170:171], a[58:59], v[156:159]
    v_cvt_pk_bf16_f32 v175, v166, v167
    v_accvgpr_write_b32 a148, v172
    v_accvgpr_write_b32 a149, v173
    v_mov_b32 v179, v178
    v_mfma_f32_4x4x4_16b_bf16 v[164:167], v[168:169], a[62:63], 0
    v_cvt_pk_bf16_f32 v172, v152, v153
    v_mfma_f32_4x4x4_16b_bf16 v[160:163], v[170:171], a[60:61], v[160:163]
    v_cvt_pk_bf16_f32 v173, v154, v155
    v_accvgpr_write_b32 a150, v174
    v_accvgpr_write_b32 a151, v175
    v_permlane16_swap_b32 v178, v179
    s_nop 1
    v_mfma_f32_4x4x4_16b_bf16 v[152:155], v[168:169], a[64:65], 0
    v_cvt_pk_bf16_f32 v174, v156, v157
    v_mfma_f32_4x4x4_16b_bf16 v[164:167], v[170:171], a[62:63], v[164:167]
    v_cvt_pk_bf16_f32 v175, v158, v159
    v_accvgpr_write_b32 a152, v172
    v_accvgpr_write_b32 a153, v173
    v_max_f32 v178, v178, v179
    v_mul_f32 v216, s28, v178
    v_mfma_f32_4x4x4_16b_bf16 v[156:159], v[168:169], a[66:67], 0
    v_cvt_pk_bf16_f32 v172, v160, v161
    v_mfma_f32_4x4x4_16b_bf16 v[152:155], v[170:171], a[64:65], v[152:155]
    v_cvt_pk_bf16_f32 v173, v162, v163
    v_accvgpr_write_b32 a154, v174
    v_accvgpr_write_b32 a155, v175
    v_mul_f32 v217, s28, v178
    v_mfma_f32_4x4x4_16b_bf16 v[160:163], v[168:169], a[68:69], 0
    v_cvt_pk_bf16_f32 v174, v164, v165
    v_mfma_f32_4x4x4_16b_bf16 v[156:159], v[170:171], a[66:67], v[156:159]
    v_cvt_pk_bf16_f32 v175, v166, v167
    v_accvgpr_write_b32 a156, v172
    v_accvgpr_write_b32 a157, v173
    v_mul_f32 v218, s28, v178
    v_mfma_f32_4x4x4_16b_bf16 v[164:167], v[168:169], a[70:71], 0
    v_cvt_pk_bf16_f32 v172, v152, v153
    v_mfma_f32_4x4x4_16b_bf16 v[160:163], v[170:171], a[68:69], v[160:163]
    v_cvt_pk_bf16_f32 v173, v154, v155
    v_accvgpr_write_b32 a158, v174
    v_accvgpr_write_b32 a159, v175
    v_mul_f32 v219, s28, v178
    v_mov_b32 v232, 0
    v_cvt_pk_bf16_f32 v174, v156, v157
    v_mfma_f32_4x4x4_16b_bf16 v[164:167], v[170:171], a[70:71], v[164:167]
    v_cvt_pk_bf16_f32 v175, v158, v159
    v_accvgpr_write_b32 a160, v172
    v_accvgpr_write_b32 a161, v173
    v_mfma_f32_16x16x32_bf16 v[220:223], a[232:235], a[72:75], 0
    v_cvt_pk_bf16_f32 v172, v160, v161
    v_mfma_f32_16x16x32_bf16 v[220:223], a[236:239], a[76:79], v[220:223]
    v_cvt_pk_bf16_f32 v173, v162, v163
    v_accvgpr_write_b32 a162, v174
    v_mfma_f32_16x16x32_bf16 v[220:223], a[240:243], a[80:83], v[220:223]
    v_accvgpr_write_b32 a163, v175
    v_cvt_pk_bf16_f32 v174, v164, v165
    v_mfma_f32_16x16x32_bf16 v[220:223], a[244:247], a[84:87], v[220:223]
    v_cvt_pk_bf16_f32 v175, v166, v167
    v_mfma_f32_16x16x32_bf16 v[220:223], a[248:251], a[88:91], v[220:223]
    v_accvgpr_write_b32 a164, v172
    v_accvgpr_write_b32 a165, v173
    v_mfma_f32_16x16x32_bf16 v[220:223], a[252:255], a[92:95], v[220:223]
    v_accvgpr_write_b32 a166, v174
    v_accvgpr_write_b32 a167, v175
    v_mfma_f32_4x4x4_16b_bf16 v[152:155], v[168:169], a[72:73], 0
    v_mfma_f32_4x4x4_16b_bf16 v[156:159], v[168:169], a[74:75], 0
    s_nop 0
    v_mfma_f32_4x4x4_16b_bf16 v[152:155], v[170:171], a[72:73], v[152:155]
    v_mfma_f32_4x4x4_16b_bf16 v[160:163], v[168:169], a[76:77], 0
    v_mfma_f32_4x4x4_16b_bf16 v[156:159], v[170:171], a[74:75], v[156:159]
    v_max3_f32 v178, v220, v221, v222
    v_mfma_f32_4x4x4_16b_bf16 v[164:167], v[168:169], a[78:79], 0
    s_nop 0
    v_cvt_pk_bf16_f32 v172, v152, v153
    v_mfma_f32_4x4x4_16b_bf16 v[160:163], v[170:171], a[76:77], v[160:163]
    v_cvt_pk_bf16_f32 v173, v154, v155
    v_max_f32 v178, v178, v223
    v_mfma_f32_4x4x4_16b_bf16 v[152:155], v[168:169], a[80:81], 0
    v_cvt_pk_bf16_f32 v174, v156, v157
    v_mfma_f32_4x4x4_16b_bf16 v[164:167], v[170:171], a[78:79], v[164:167]
    v_cvt_pk_bf16_f32 v175, v158, v159
    v_accvgpr_write_b32 a168, v172
    v_accvgpr_write_b32 a169, v173
    v_mov_b32 v179, v178
    v_mfma_f32_4x4x4_16b_bf16 v[156:159], v[168:169], a[82:83], 0
    v_cvt_pk_bf16_f32 v172, v160, v161
    v_mfma_f32_4x4x4_16b_bf16 v[152:155], v[170:171], a[80:81], v[152:155]
    v_cvt_pk_bf16_f32 v173, v162, v163
    v_accvgpr_write_b32 a170, v174
    v_accvgpr_write_b32 a171, v175
    v_permlane32_swap_b32 v178, v179
    v_max_f32 v178, v178, v179
    s_nop 0
    v_mfma_f32_4x4x4_16b_bf16 v[160:163], v[168:169], a[84:85], 0
    v_cvt_pk_bf16_f32 v174, v164, v165
    v_mfma_f32_4x4x4_16b_bf16 v[156:159], v[170:171], a[82:83], v[156:159]
    v_cvt_pk_bf16_f32 v175, v166, v167
    v_accvgpr_write_b32 a172, v172
    v_accvgpr_write_b32 a173, v173
    v_mov_b32 v179, v178
    v_mfma_f32_4x4x4_16b_bf16 v[164:167], v[168:169], a[86:87], 0
    v_cvt_pk_bf16_f32 v172, v152, v153
    v_mfma_f32_4x4x4_16b_bf16 v[160:163], v[170:171], a[84:85], v[160:163]
    v_cvt_pk_bf16_f32 v173, v154, v155
    v_accvgpr_write_b32 a174, v174
    v_accvgpr_write_b32 a175, v175
    v_permlane16_swap_b32 v178, v179
    s_nop 1
    v_mfma_f32_4x4x4_16b_bf16 v[152:155], v[168:169], a[88:89], 0
    v_cvt_pk_bf16_f32 v174, v156, v157
    v_mfma_f32_4x4x4_16b_bf16 v[164:167], v[170:171], a[86:87], v[164:167]
    v_cvt_pk_bf16_f32 v175, v158, v159
    v_accvgpr_write_b32 a176, v172
    v_accvgpr_write_b32 a177, v173
    v_max_f32 v178, v178, v179
    v_mul_f32 v220, s28, v178
    v_mfma_f32_4x4x4_16b_bf16 v[156:159], v[168:169], a[90:91], 0
    v_cvt_pk_bf16_f32 v172, v160, v161
    v_mfma_f32_4x4x4_16b_bf16 v[152:155], v[170:171], a[88:89], v[152:155]
    v_cvt_pk_bf16_f32 v173, v162, v163
    v_accvgpr_write_b32 a178, v174
    v_accvgpr_write_b32 a179, v175
    v_mul_f32 v221, s28, v178
    v_mfma_f32_4x4x4_16b_bf16 v[160:163], v[168:169], a[92:93], 0
    v_cvt_pk_bf16_f32 v174, v164, v165
    v_mfma_f32_4x4x4_16b_bf16 v[156:159], v[170:171], a[90:91], v[156:159]
    v_cvt_pk_bf16_f32 v175, v166, v167
    v_accvgpr_write_b32 a180, v172
    v_accvgpr_write_b32 a181, v173
    v_mul_f32 v222, s28, v178
    v_mfma_f32_4x4x4_16b_bf16 v[164:167], v[168:169], a[94:95], 0
    v_cvt_pk_bf16_f32 v172, v152, v153
    v_mfma_f32_4x4x4_16b_bf16 v[160:163], v[170:171], a[92:93], v[160:163]
    v_cvt_pk_bf16_f32 v173, v154, v155
    v_accvgpr_write_b32 a182, v174
    v_accvgpr_write_b32 a183, v175
    v_mul_f32 v223, s28, v178
    v_mov_b32 v233, 0
    v_cvt_pk_bf16_f32 v174, v156, v157
    v_mfma_f32_4x4x4_16b_bf16 v[164:167], v[170:171], a[94:95], v[164:167]
    v_cvt_pk_bf16_f32 v175, v158, v159
    v_accvgpr_write_b32 a184, v172
    v_accvgpr_write_b32 a185, v173
    v_mfma_f32_16x16x32_bf16 v[224:227], a[232:235], a[96:99], 0
    v_cvt_pk_bf16_f32 v172, v160, v161
    v_mfma_f32_16x16x32_bf16 v[224:227], a[236:239], a[100:103], v[224:227]
    v_cvt_pk_bf16_f32 v173, v162, v163
    v_accvgpr_write_b32 a186, v174
    v_mfma_f32_16x16x32_bf16 v[224:227], a[240:243], a[104:107], v[224:227]
    v_accvgpr_write_b32 a187, v175
    v_cvt_pk_bf16_f32 v174, v164, v165
    v_mfma_f32_16x16x32_bf16 v[224:227], a[244:247], a[108:111], v[224:227]
    v_cvt_pk_bf16_f32 v175, v166, v167
    v_mfma_f32_16x16x32_bf16 v[224:227], a[248:251], a[112:115], v[224:227]
    v_accvgpr_write_b32 a188, v172
    v_accvgpr_write_b32 a189, v173
    v_mfma_f32_16x16x32_bf16 v[224:227], a[252:255], a[116:119], v[224:227]
    v_accvgpr_write_b32 a190, v174
    v_accvgpr_write_b32 a191, v175
    v_mfma_f32_4x4x4_16b_bf16 v[152:155], v[168:169], a[96:97], 0
    v_mfma_f32_4x4x4_16b_bf16 v[156:159], v[168:169], a[98:99], 0
    s_nop 0
    v_mfma_f32_4x4x4_16b_bf16 v[152:155], v[170:171], a[96:97], v[152:155]
    v_mfma_f32_4x4x4_16b_bf16 v[160:163], v[168:169], a[100:101], 0
    v_mfma_f32_4x4x4_16b_bf16 v[156:159], v[170:171], a[98:99], v[156:159]
    v_max3_f32 v178, v224, v225, v226
    v_mfma_f32_4x4x4_16b_bf16 v[164:167], v[168:169], a[102:103], 0
    s_nop 0
    v_cvt_pk_bf16_f32 v172, v152, v153
    v_mfma_f32_4x4x4_16b_bf16 v[160:163], v[170:171], a[100:101], v[160:163]
    v_cvt_pk_bf16_f32 v173, v154, v155
    v_max_f32 v178, v178, v227
    v_mfma_f32_4x4x4_16b_bf16 v[152:155], v[168:169], a[104:105], 0
    v_cvt_pk_bf16_f32 v174, v156, v157
    v_mfma_f32_4x4x4_16b_bf16 v[164:167], v[170:171], a[102:103], v[164:167]
    v_cvt_pk_bf16_f32 v175, v158, v159
    v_accvgpr_write_b32 a192, v172
    v_accvgpr_write_b32 a193, v173
    v_mov_b32 v179, v178
    v_mfma_f32_4x4x4_16b_bf16 v[156:159], v[168:169], a[106:107], 0
    v_cvt_pk_bf16_f32 v172, v160, v161
    v_mfma_f32_4x4x4_16b_bf16 v[152:155], v[170:171], a[104:105], v[152:155]
    v_cvt_pk_bf16_f32 v173, v162, v163
    v_accvgpr_write_b32 a194, v174
    v_accvgpr_write_b32 a195, v175
    v_permlane32_swap_b32 v178, v179
    v_max_f32 v178, v178, v179
    s_nop 0
    v_mfma_f32_4x4x4_16b_bf16 v[160:163], v[168:169], a[108:109], 0
    v_cvt_pk_bf16_f32 v174, v164, v165
    v_mfma_f32_4x4x4_16b_bf16 v[156:159], v[170:171], a[106:107], v[156:159]
    v_cvt_pk_bf16_f32 v175, v166, v167
    v_accvgpr_write_b32 a196, v172
    v_accvgpr_write_b32 a197, v173
    v_mov_b32 v179, v178
    v_mfma_f32_4x4x4_16b_bf16 v[164:167], v[168:169], a[110:111], 0
    v_cvt_pk_bf16_f32 v172, v152, v153
    v_mfma_f32_4x4x4_16b_bf16 v[160:163], v[170:171], a[108:109], v[160:163]
    v_cvt_pk_bf16_f32 v173, v154, v155
    v_accvgpr_write_b32 a198, v174
    v_accvgpr_write_b32 a199, v175
    v_permlane16_swap_b32 v178, v179
    s_nop 1
    v_mfma_f32_4x4x4_16b_bf16 v[152:155], v[168:169], a[112:113], 0
    v_cvt_pk_bf16_f32 v174, v156, v157
    v_mfma_f32_4x4x4_16b_bf16 v[164:167], v[170:171], a[110:111], v[164:167]
    v_cvt_pk_bf16_f32 v175, v158, v159
    v_accvgpr_write_b32 a200, v172
    v_accvgpr_write_b32 a201, v173
    v_max_f32 v178, v178, v179
    v_mul_f32 v224, s28, v178
    v_mfma_f32_4x4x4_16b_bf16 v[156:159], v[168:169], a[114:115], 0
    v_cvt_pk_bf16_f32 v172, v160, v161
    v_mfma_f32_4x4x4_16b_bf16 v[152:155], v[170:171], a[112:113], v[152:155]
    v_cvt_pk_bf16_f32 v173, v162, v163
    v_accvgpr_write_b32 a202, v174
    v_accvgpr_write_b32 a203, v175
    v_mul_f32 v225, s28, v178
    v_mfma_f32_4x4x4_16b_bf16 v[160:163], v[168:169], a[116:117], 0
    v_cvt_pk_bf16_f32 v174, v164, v165
    v_mfma_f32_4x4x4_16b_bf16 v[156:159], v[170:171], a[114:115], v[156:159]
    v_cvt_pk_bf16_f32 v175, v166, v167
    v_accvgpr_write_b32 a204, v172
    v_accvgpr_write_b32 a205, v173
    v_mul_f32 v226, s28, v178
    v_mfma_f32_4x4x4_16b_bf16 v[164:167], v[168:169], a[118:119], 0
    v_cvt_pk_bf16_f32 v172, v152, v153
    v_mfma_f32_4x4x4_16b_bf16 v[160:163], v[170:171], a[116:117], v[160:163]
    v_cvt_pk_bf16_f32 v173, v154, v155
    v_accvgpr_write_b32 a206, v174
    v_accvgpr_write_b32 a207, v175
    v_mul_f32 v227, s28, v178
    v_mov_b32 v234, 0
    v_cvt_pk_bf16_f32 v174, v156, v157
    v_mfma_f32_4x4x4_16b_bf16 v[164:167], v[170:171], a[118:119], v[164:167]
    v_cvt_pk_bf16_f32 v175, v158, v159
    v_accvgpr_write_b32 a208, v172
    v_accvgpr_write_b32 a209, v173
    v_mfma_f32_16x16x32_bf16 v[228:231], a[232:235], a[120:123], 0
    v_cvt_pk_bf16_f32 v172, v160, v161
    v_mfma_f32_16x16x32_bf16 v[228:231], a[236:239], a[124:127], v[228:231]
    v_cvt_pk_bf16_f32 v173, v162, v163
    v_accvgpr_write_b32 a210, v174
    v_mfma_f32_16x16x32_bf16 v[228:231], a[240:243], a[128:131], v[228:231]
    v_accvgpr_write_b32 a211, v175
    v_cvt_pk_bf16_f32 v174, v164, v165
    v_mfma_f32_16x16x32_bf16 v[228:231], a[244:247], a[132:135], v[228:231]
    v_cvt_pk_bf16_f32 v175, v166, v167
    v_mfma_f32_16x16x32_bf16 v[228:231], a[248:251], a[136:139], v[228:231]
    v_accvgpr_write_b32 a212, v172
    v_accvgpr_write_b32 a213, v173
    v_mfma_f32_16x16x32_bf16 v[228:231], a[252:255], a[140:143], v[228:231]
    v_accvgpr_write_b32 a214, v174
    v_accvgpr_write_b32 a215, v175
    v_mfma_f32_4x4x4_16b_bf16 v[152:155], v[168:169], a[120:121], 0
    v_mfma_f32_4x4x4_16b_bf16 v[156:159], v[168:169], a[122:123], 0
    s_nop 0
    v_mfma_f32_4x4x4_16b_bf16 v[152:155], v[170:171], a[120:121], v[152:155]
    v_mfma_f32_4x4x4_16b_bf16 v[160:163], v[168:169], a[124:125], 0
    v_mfma_f32_4x4x4_16b_bf16 v[156:159], v[170:171], a[122:123], v[156:159]
    v_max3_f32 v178, v228, v229, v230
    v_mfma_f32_4x4x4_16b_bf16 v[164:167], v[168:169], a[126:127], 0
    s_nop 0
    v_cvt_pk_bf16_f32 v172, v152, v153
    v_mfma_f32_4x4x4_16b_bf16 v[160:163], v[170:171], a[124:125], v[160:163]
    v_cvt_pk_bf16_f32 v173, v154, v155
    v_max_f32 v178, v178, v231
    v_mfma_f32_4x4x4_16b_bf16 v[152:155], v[168:169], a[128:129], 0
    v_cvt_pk_bf16_f32 v174, v156, v157
    v_mfma_f32_4x4x4_16b_bf16 v[164:167], v[170:171], a[126:127], v[164:167]
    v_cvt_pk_bf16_f32 v175, v158, v159
    v_accvgpr_write_b32 a216, v172
    v_accvgpr_write_b32 a217, v173
    v_mov_b32 v179, v178
    v_mfma_f32_4x4x4_16b_bf16 v[156:159], v[168:169], a[130:131], 0
    v_cvt_pk_bf16_f32 v172, v160, v161
    v_mfma_f32_4x4x4_16b_bf16 v[152:155], v[170:171], a[128:129], v[152:155]
    v_cvt_pk_bf16_f32 v173, v162, v163
    v_accvgpr_write_b32 a218, v174
    v_accvgpr_write_b32 a219, v175
    v_permlane32_swap_b32 v178, v179
    v_max_f32 v178, v178, v179
    s_nop 0
    v_mfma_f32_4x4x4_16b_bf16 v[160:163], v[168:169], a[132:133], 0
    v_cvt_pk_bf16_f32 v174, v164, v165
    v_mfma_f32_4x4x4_16b_bf16 v[156:159], v[170:171], a[130:131], v[156:159]
    v_cvt_pk_bf16_f32 v175, v166, v167
    v_accvgpr_write_b32 a220, v172
    v_accvgpr_write_b32 a221, v173
    v_mov_b32 v179, v178
    v_mfma_f32_4x4x4_16b_bf16 v[164:167], v[168:169], a[134:135], 0
    v_cvt_pk_bf16_f32 v172, v152, v153
    v_mfma_f32_4x4x4_16b_bf16 v[160:163], v[170:171], a[132:133], v[160:163]
    v_cvt_pk_bf16_f32 v173, v154, v155
    v_accvgpr_write_b32 a222, v174
    v_accvgpr_write_b32 a223, v175
    v_permlane16_swap_b32 v178, v179
    s_nop 1
    v_mfma_f32_4x4x4_16b_bf16 v[152:155], v[168:169], a[136:137], 0
    v_cvt_pk_bf16_f32 v174, v156, v157
    v_mfma_f32_4x4x4_16b_bf16 v[164:167], v[170:171], a[134:135], v[164:167]
    v_cvt_pk_bf16_f32 v175, v158, v159
    v_accvgpr_write_b32 a224, v172
    v_accvgpr_write_b32 a225, v173
    v_max_f32 v178, v178, v179
    v_mul_f32 v228, s28, v178
    v_mfma_f32_4x4x4_16b_bf16 v[156:159], v[168:169], a[138:139], 0
    v_cvt_pk_bf16_f32 v172, v160, v161
    v_mfma_f32_4x4x4_16b_bf16 v[152:155], v[170:171], a[136:137], v[152:155]
    v_cvt_pk_bf16_f32 v173, v162, v163
    v_accvgpr_write_b32 a226, v174
    v_accvgpr_write_b32 a227, v175
    v_mul_f32 v229, s28, v178
    v_mfma_f32_4x4x4_16b_bf16 v[160:163], v[168:169], a[140:141], 0
    v_cvt_pk_bf16_f32 v174, v164, v165
    v_mfma_f32_4x4x4_16b_bf16 v[156:159], v[170:171], a[138:139], v[156:159]
    v_cvt_pk_bf16_f32 v175, v166, v167
    v_accvgpr_write_b32 a228, v172
    v_accvgpr_write_b32 a229, v173
    v_mul_f32 v230, s28, v178
    v_mfma_f32_4x4x4_16b_bf16 v[164:167], v[168:169], a[142:143], 0
    v_cvt_pk_bf16_f32 v144, v152, v153
    v_mfma_f32_4x4x4_16b_bf16 v[160:163], v[170:171], a[140:141], v[160:163]
    v_cvt_pk_bf16_f32 v145, v154, v155
    v_accvgpr_write_b32 a230, v174
    v_accvgpr_write_b32 a231, v175
    v_mul_f32 v231, s28, v178
    v_mov_b32 v235, 0
    v_cvt_pk_bf16_f32 v146, v156, v157
    v_mfma_f32_4x4x4_16b_bf16 v[164:167], v[170:171], a[142:143], v[164:167]
    v_cvt_pk_bf16_f32 v147, v158, v159
    v_cvt_pk_bf16_f32 v148, v160, v161
    v_cvt_pk_bf16_f32 v149, v162, v163
    s_nop 1
    v_cvt_pk_bf16_f32 v150, v164, v165
    v_cvt_pk_bf16_f32 v151, v166, v167
    s_setpc_b64 s[62:63]
L_pk:
    v_add_u32 v254, s100, v245
    ds_write_b32 v247, v252 offset:0
    ds_write_b128 v254, a[24:27] offset:0
    v_mov_b32 v204, v249
    v_mov_b32 v212, 0
    v_mov_b32 v205, v250
    v_permlane32_swap_b32 v249, v204
    v_mov_b32 v213, 0
    v_permlane32_swap_b32 v250, v205
    v_add_f32 v249, v249, v204
    v_mov_b32 v214, 0
    v_add_f32 v250, v250, v205
    v_mov_b32 v204, v249
    v_mov_b32 v215, 0
    v_mov_b32 v205, v250
    v_permlane16_swap_b32 v249, v204
    s_nop 0
    v_permlane16_swap_b32 v250, v205
    v_add_f32 v249, v249, v204
    v_add_f32 v250, v250, v205
    v_rcp_f32 v200, v249
    v_rcp_f32 v201, v250
    v_pk_mul_f32 v[184:185], v[0:1], v[200:201] op_sel_hi:[1,0]
    v_pk_mul_f32 v[186:187], v[2:3], v[200:201] op_sel_hi:[1,0]
    v_pk_mul_f32 v[188:189], v[4:5], v[200:201] op_sel_hi:[1,0]
    v_pk_mul_f32 v[190:191], v[6:7], v[200:201] op_sel_hi:[1,0]
    v_cvt_pk_bf16_f32 v184, v184, v185
    v_cvt_pk_bf16_f32 v185, v186, v187
    v_cvt_pk_bf16_f32 v186, v188, v189
    v_cvt_pk_bf16_f32 v187, v190, v191
    ds_write_b128 v254, a[28:31] offset:1024
    v_cmp_nle_f32 s[60:61], v249, s48
    v_cmp_nge_f32 s[80:81], v249, s29
    s_nop 0
    s_or_b64 s[78:79], s[78:79], s[60:61]
    v_pk_mul_f32 v[192:193], v[8:9], v[200:201] op_sel_hi:[1,0]
    v_pk_mul_f32 v[194:195], v[10:11], v[200:201] op_sel_hi:[1,0]
    v_pk_mul_f32 v[196:197], v[12:13], v[200:201] op_sel_hi:[1,0]
    v_pk_mul_f32 v[198:199], v[14:15], v[200:201] op_sel_hi:[1,0]
    v_permlane16_swap_b32 v184, v186
    v_permlane16_swap_b32 v185, v187
    v_cvt_pk_bf16_f32 v192, v192, v193
    v_cvt_pk_bf16_f32 v193, v194, v195
    v_cvt_pk_bf16_f32 v194, v196, v197
    v_cvt_pk_bf16_f32 v195, v198, v199
    v_accvgpr_write_b32 a48, v184
    v_accvgpr_write_b32 a49, v185
    v_accvgpr_write_b32 a50, v186
    v_accvgpr_write_b32 a51, v187
    ds_write_b128 v254, a[32:35] offset:2048
    s_or_b64 s[78:79], s[78:79], s[80:81]
    v_cmp_nle_f32 s[60:61], v250, s48
    v_cmp_nge_f32 s[80:81], v250, s29
    v_pk_mul_f32 v[184:185], v[16:17], v[200:201] op_sel_hi:[1,0]
    v_pk_mul_f32 v[186:187], v[18:19], v[200:201] op_sel_hi:[1,0]
    v_pk_mul_f32 v[188:189], v[20:21], v[200:201] op_sel_hi:[1,0]
    v_pk_mul_f32 v[190:191], v[22:23], v[200:201] op_sel_hi:[1,0]
    v_permlane16_swap_b32 v192, v194
    v_permlane16_swap_b32 v193, v195
    v_cvt_pk_bf16_f32 v184, v184, v185
    v_cvt_pk_bf16_f32 v185, v186, v187
    v_cvt_pk_bf16_f32 v186, v188, v189
    v_cvt_pk_bf16_f32 v187, v190, v191
    v_accvgpr_write_b32 a52, v192
    v_accvgpr_write_b32 a53, v193
    v_accvgpr_write_b32 a54, v194
    v_accvgpr_write_b32 a55, v195
    ds_write_b128 v254, a[36:39] offset:3072
    s_or_b64 s[78:79], s[78:79], s[60:61]
    s_or_b64 s[78:79], s[78:79], s[80:81]
    v_mov_b32 v206, v251
    v_pk_mul_f32 v[192:193], v[24:25], v[200:201] op_sel_hi:[1,0]
    v_pk_mul_f32 v[194:195], v[26:27], v[200:201] op_sel_hi:[1,0]
    v_pk_mul_f32 v[196:197], v[28:29], v[200:201] op_sel_hi:[1,0]
    v_pk_mul_f32 v[198:199], v[30:31], v[200:201] op_sel_hi:[1,0]
    v_permlane16_swap_b32 v184, v186
    v_permlane16_swap_b32 v185, v187
    v_cvt_pk_bf16_f32 v192, v192, v193
    v_cvt_pk_bf16_f32 v193, v194, v195
    v_cvt_pk_bf16_f32 v194, v196, v197
    v_cvt_pk_bf16_f32 v195, v198, v199
    v_accvgpr_write_b32 a56, v184
    v_accvgpr_write_b32 a57, v185
    v_accvgpr_write_b32 a58, v186
    v_accvgpr_write_b32 a59, v187
    ds_write_b128 v254, a[40:43] offset:4096
    v_permlane32_swap_b32 v251, v206
    v_add_f32 v251, v251, v206
    v_mov_b32 v206, v251
    v_pk_mul_f32 v[184:185], v[32:33], v[200:201] op_sel_hi:[1,0]
    v_pk_mul_f32 v[186:187], v[34:35], v[200:201] op_sel_hi:[1,0]
    v_pk_mul_f32 v[188:189], v[36:37], v[200:201] op_sel_hi:[1,0]
    v_pk_mul_f32 v[190:191], v[38:39], v[200:201] op_sel_hi:[1,0]
    v_permlane16_swap_b32 v192, v194
    v_permlane16_swap_b32 v193, v195
    v_cvt_pk_bf16_f32 v184, v184, v185
    v_cvt_pk_bf16_f32 v185, v186, v187
    v_cvt_pk_bf16_f32 v186, v188, v189
    v_cvt_pk_bf16_f32 v187, v190, v191
    v_accvgpr_write_b32 a60, v192
    v_accvgpr_write_b32 a61, v193
    v_accvgpr_write_b32 a62, v194
    v_accvgpr_write_b32 a63, v195
    ds_write_b128 v254, a[44:47] offset:5120
    v_permlane16_swap_b32 v251, v206
    v_add_f32 v251, v251, v206
    v_rcp_f32 v202, v251
    v_pk_mul_f32 v[192:193], v[40:41], v[200:201] op_sel_hi:[1,0]
    v_pk_mul_f32 v[194:195], v[42:43], v[200:201] op_sel_hi:[1,0]
    v_pk_mul_f32 v[196:197], v[44:45], v[200:201] op_sel_hi:[1,0]
    v_pk_mul_f32 v[198:199], v[46:47], v[200:201] op_sel_hi:[1,0]
    v_permlane16_swap_b32 v184, v186
    v_permlane16_swap_b32 v185, v187
    v_cvt_pk_bf16_f32 v192, v192, v193
    v_cvt_pk_bf16_f32 v193, v194, v195
    v_mfma_f32_32x32x16_bf16 v[32:47], v[212:215], v[212:215], 0
    v_cvt_pk_bf16_f32 v194, v196, v197
    v_cvt_pk_bf16_f32 v195, v198, v199
    v_accvgpr_write_b32 a64, v184
    v_accvgpr_write_b32 a65, v185
    v_accvgpr_write_b32 a66, v186
    v_accvgpr_write_b32 a67, v187
    v_cmp_nle_f32 s[60:61], v251, s48
    v_cmp_nge_f32 s[80:81], v251, s29
    s_nop 0
    s_or_b64 s[78:79], s[78:79], s[60:61]
    s_or_b64 s[78:79], s[78:79], s[80:81]
    v_pk_mul_f32 v[184:185], v[48:49], v[200:201] op_sel:[0,1] op_sel_hi:[1,1]
    v_pk_mul_f32 v[186:187], v[50:51], v[200:201] op_sel:[0,1] op_sel_hi:[1,1]
    v_pk_mul_f32 v[188:189], v[52:53], v[200:201] op_sel:[0,1] op_sel_hi:[1,1]
    v_pk_mul_f32 v[190:191], v[54:55], v[200:201] op_sel:[0,1] op_sel_hi:[1,1]
    v_permlane16_swap_b32 v192, v194
    v_permlane16_swap_b32 v193, v195
    v_cvt_pk_bf16_f32 v184, v184, v185
    v_cvt_pk_bf16_f32 v185, v186, v187
    v_cvt_pk_bf16_f32 v186, v188, v189
    v_cvt_pk_bf16_f32 v187, v190, v191
    v_accvgpr_write_b32 a68, v192
    v_accvgpr_write_b32 a69, v193
    v_accvgpr_write_b32 a70, v194
    v_accvgpr_write_b32 a71, v195
    v_pk_mul_f32 v[192:193], v[56:57], v[200:201] op_sel:[0,1] op_sel_hi:[1,1]
    v_pk_mul_f32 v[194:195], v[58:59], v[200:201] op_sel:[0,1] op_sel_hi:[1,1]
    v_pk_mul_f32 v[196:197], v[60:61], v[200:201] op_sel:[0,1] op_sel_hi:[1,1]
    v_pk_mul_f32 v[198:199], v[62:63], v[200:201] op_sel:[0,1] op_sel_hi:[1,1]
    v_permlane16_swap_b32 v184, v186
    v_permlane16_swap_b32 v185, v187
    v_cvt_pk_bf16_f32 v192, v192, v193
    v_cvt_pk_bf16_f32 v193, v194, v195
    v_mfma_f32_32x32x16_bf16 v[48:63], v[212:215], v[212:215], 0
    v_cvt_pk_bf16_f32 v194, v196, v197
    v_cvt_pk_bf16_f32 v195, v198, v199
    v_accvgpr_write_b32 a72, v184
    v_accvgpr_write_b32 a73, v185
    v_accvgpr_write_b32 a74, v186
    v_accvgpr_write_b32 a75, v187
    s_waitcnt lgkmcnt(0)
    s_barrier
    v_xor_b32 v254, 256, v247
    ds_read_b32 v207, v254 offset:0
    v_add_u32 v254, s101, v245
    ds_read_b128 v[0:3], v254 offset:0
    ds_read_b128 v[4:7], v254 offset:1024
    ds_read_b128 v[8:11], v254 offset:2048
    ds_read_b128 v[12:15], v254 offset:3072
    ds_read_b128 v[16:19], v254 offset:4096
    ds_read_b128 v[20:23], v254 offset:5120
    v_pk_mul_f32 v[184:185], v[64:65], v[200:201] op_sel:[0,1] op_sel_hi:[1,1]
    v_pk_mul_f32 v[186:187], v[66:67], v[200:201] op_sel:[0,1] op_sel_hi:[1,1]
    v_pk_mul_f32 v[188:189], v[68:69], v[200:201] op_sel:[0,1] op_sel_hi:[1,1]
    v_pk_mul_f32 v[190:191], v[70:71], v[200:201] op_sel:[0,1] op_sel_hi:[1,1]
    v_permlane16_swap_b32 v192, v194
    v_permlane16_swap_b32 v193, v195
    v_cvt_pk_bf16_f32 v184, v184, v185
    v_cvt_pk_bf16_f32 v185, v186, v187
    v_cvt_pk_bf16_f32 v186, v188, v189
    v_cvt_pk_bf16_f32 v187, v190, v191
    buffer_store_dwordx4 v[192:195], v244, s[20:23], s33 offen offset:64 sc1
    s_nop 1
    v_pk_mul_f32 v[192:193], v[72:73], v[200:201] op_sel:[0,1] op_sel_hi:[1,1]
    v_pk_mul_f32 v[194:195], v[74:75], v[200:201] op_sel:[0,1] op_sel_hi:[1,1]
    v_pk_mul_f32 v[196:197], v[76:77], v[200:201] op_sel:[0,1] op_sel_hi:[1,1]
    v_pk_mul_f32 v[198:199], v[78:79], v[200:201] op_sel:[0,1] op_sel_hi:[1,1]
    v_permlane16_swap_b32 v184, v186
    v_permlane16_swap_b32 v185, v187
    v_cvt_pk_bf16_f32 v192, v192, v193
    v_cvt_pk_bf16_f32 v193, v194, v195
    v_mfma_f32_32x32x16_bf16 v[64:79], v[212:215], v[212:215], 0
    v_cvt_pk_bf16_f32 v194, v196, v197
    v_cvt_pk_bf16_f32 v195, v198, v199
    v_accvgpr_write_b32 a80, v184
    v_accvgpr_write_b32 a81, v185
    v_accvgpr_write_b32 a82, v186
    v_accvgpr_write_b32 a83, v187
    v_pk_mul_f32 v[184:185], v[80:81], v[200:201] op_sel:[0,1] op_sel_hi:[1,1]
    v_pk_mul_f32 v[186:187], v[82:83], v[200:201] op_sel:[0,1] op_sel_hi:[1,1]
    v_pk_mul_f32 v[188:189], v[84:85], v[200:201] op_sel:[0,1] op_sel_hi:[1,1]
    v_pk_mul_f32 v[190:191], v[86:87], v[200:201] op_sel:[0,1] op_sel_hi:[1,1]
    v_permlane16_swap_b32 v192, v194
    v_permlane16_swap_b32 v193, v195
    v_cvt_pk_bf16_f32 v184, v184, v185
    v_cvt_pk_bf16_f32 v185, v186, v187
    v_mfma_f32_32x32x16_bf16 a[32:47], v[212:215], v[212:215], 0
    v_cvt_pk_bf16_f32 v186, v188, v189
    v_cvt_pk_bf16_f32 v187, v190, v191
    buffer_store_dwordx4 v[192:195], v244, s[20:23], s33 offen offset:192 sc1
    s_nop 1
    v_pk_mul_f32 v[192:193], v[88:89], v[200:201] op_sel:[0,1] op_sel_hi:[1,1]
    v_pk_mul_f32 v[194:195], v[90:91], v[200:201] op_sel:[0,1] op_sel_hi:[1,1]
    v_pk_mul_f32 v[196:197], v[92:93], v[200:201] op_sel:[0,1] op_sel_hi:[1,1]
    v_pk_mul_f32 v[198:199], v[94:95], v[200:201] op_sel:[0,1] op_sel_hi:[1,1]
    v_permlane16_swap_b32 v184, v186
    v_permlane16_swap_b32 v185, v187
    v_cvt_pk_bf16_f32 v192, v192, v193
    v_cvt_pk_bf16_f32 v193, v194, v195
    v_mfma_f32_32x32x16_bf16 v[80:95], v[212:215], v[212:215], 0
    v_cvt_pk_bf16_f32 v194, v196, v197
    v_cvt_pk_bf16_f32 v195, v198, v199
    v_accvgpr_write_b32 a88, v184
    v_accvgpr_write_b32 a89, v185
    v_accvgpr_write_b32 a90, v186
    v_accvgpr_write_b32 a91, v187
    s_waitcnt lgkmcnt(0)
    s_barrier
    v_add_f32 v252, v252, v207
    v_mov_b32 v204, v252
    v_pk_mul_f32 v[184:185], v[96:97], v[202:203] op_sel_hi:[1,0]
    v_pk_mul_f32 v[186:187], v[98:99], v[202:203] op_sel_hi:[1,0]
    v_pk_mul_f32 v[188:189], v[100:101], v[202:203] op_sel_hi:[1,0]
    v_pk_mul_f32 v[190:191], v[102:103], v[202:203] op_sel_hi:[1,0]
    v_permlane16_swap_b32 v192, v194
    v_permlane16_swap_b32 v193, v195
    v_cvt_pk_bf16_f32 v184, v184, v185
    v_cvt_pk_bf16_f32 v185, v186, v187
    v_cvt_pk_bf16_f32 v186, v188, v189
    v_cvt_pk_bf16_f32 v187, v190, v191
    buffer_store_dwordx4 v[192:195], v244, s[20:23], s33 offen offset:320 sc1
    v_permlane32_swap_b32 v252, v204
    v_add_f32 v252, v252, v204
    v_pk_mul_f32 v[192:193], v[104:105], v[202:203] op_sel_hi:[1,0]
    v_pk_mul_f32 v[194:195], v[106:107], v[202:203] op_sel_hi:[1,0]
    v_pk_mul_f32 v[196:197], v[108:109], v[202:203] op_sel_hi:[1,0]
    v_pk_mul_f32 v[198:199], v[110:111], v[202:203] op_sel_hi:[1,0]
    v_permlane16_swap_b32 v184, v186
    v_permlane16_swap_b32 v185, v187
    v_cvt_pk_bf16_f32 v192, v192, v193
    v_cvt_pk_bf16_f32 v193, v194, v195
    v_mfma_f32_32x32x16_bf16 v[96:111], v[212:215], v[212:215], 0
    v_cvt_pk_bf16_f32 v194, v196, v197
    v_cvt_pk_bf16_f32 v195, v198, v199
    v_accvgpr_write_b32 a96, v184
    v_accvgpr_write_b32 a97, v185
    v_accvgpr_write_b32 a98, v186
    v_accvgpr_write_b32 a99, v187
    v_mov_b32 v204, v252
    s_nop 1
    v_permlane16_swap_b32 v252, v204
    v_pk_mul_f32 v[184:185], v[112:113], v[202:203] op_sel_hi:[1,0]
    v_pk_mul_f32 v[186:187], v[114:115], v[202:203] op_sel_hi:[1,0]
    v_pk_mul_f32 v[188:189], v[116:117], v[202:203] op_sel_hi:[1,0]
    v_pk_mul_f32 v[190:191], v[118:119], v[202:203] op_sel_hi:[1,0]
    v_permlane16_swap_b32 v192, v194
    v_permlane16_swap_b32 v193, v195
    v_cvt_pk_bf16_f32 v184, v184, v185
    v_cvt_pk_bf16_f32 v185, v186, v187
    v_cvt_pk_bf16_f32 v186, v188, v189
    v_cvt_pk_bf16_f32 v187, v190, v191
    buffer_store_dwordx4 v[192:195], v244, s[20:23], s34 offen offset:64 sc1
    v_add_f32 v252, v252, v204
    v_rcp_f32 v203, v252
    v_pk_mul_f32 v[192:193], v[120:121], v[202:203] op_sel_hi:[1,0]
    v_pk_mul_f32 v[194:195], v[122:123], v[202:203] op_sel_hi:[1,0]
    v_pk_mul_f32 v[196:197], v[124:125], v[202:203] op_sel_hi:[1,0]
    v_pk_mul_f32 v[198:199], v[126:127], v[202:203] op_sel_hi:[1,0]
    v_permlane16_swap_b32 v184, v186
    v_permlane16_swap_b32 v185, v187
    v_cvt_pk_bf16_f32 v192, v192, v193
    v_cvt_pk_bf16_f32 v193, v194, v195
    v_mfma_f32_32x32x16_bf16 v[112:127], v[212:215], v[212:215], 0
    v_cvt_pk_bf16_f32 v194, v196, v197
    v_cvt_pk_bf16_f32 v195, v198, v199
    v_accvgpr_write_b32 a104, v184
    v_accvgpr_write_b32 a105, v185
    v_accvgpr_write_b32 a106, v186
    v_accvgpr_write_b32 a107, v187
    v_cmp_nle_f32 s[60:61], v252, s48
    v_cmp_nge_f32 s[80:81], v252, s29
    v_pk_mul_f32 v[184:185], v[128:129], v[202:203] op_sel_hi:[1,0]
    v_pk_mul_f32 v[186:187], v[130:131], v[202:203] op_sel_hi:[1,0]
    v_pk_mul_f32 v[188:189], v[132:133], v[202:203] op_sel_hi:[1,0]
    v_pk_mul_f32 v[190:191], v[134:135], v[202:203] op_sel_hi:[1,0]
    v_permlane16_swap_b32 v192, v194
    v_permlane16_swap_b32 v193, v195
    v_cvt_pk_bf16_f32 v184, v184, v185
    v_cvt_pk_bf16_f32 v185, v186, v187
    v_cvt_pk_bf16_f32 v186, v188, v189
    v_cvt_pk_bf16_f32 v187, v190, v191
    buffer_store_dwordx4 v[192:195], v244, s[20:23], s34 offen offset:192 sc1
    s_or_b64 s[78:79], s[78:79], s[60:61]
    s_or_b64 s[78:79], s[78:79], s[80:81]
    v_pk_mul_f32 v[192:193], v[136:137], v[202:203] op_sel_hi:[1,0]
    v_pk_mul_f32 v[194:195], v[138:139], v[202:203] op_sel_hi:[1,0]
    v_pk_mul_f32 v[196:197], v[140:141], v[202:203] op_sel_hi:[1,0]
    v_pk_mul_f32 v[198:199], v[142:143], v[202:203] op_sel_hi:[1,0]
    v_permlane16_swap_b32 v184, v186
    v_permlane16_swap_b32 v185, v187
    v_cvt_pk_bf16_f32 v192, v192, v193
    v_cvt_pk_bf16_f32 v193, v194, v195
    v_mfma_f32_32x32x16_bf16 v[128:143], v[212:215], v[212:215], 0
    v_cvt_pk_bf16_f32 v194, v196, v197
    v_cvt_pk_bf16_f32 v195, v198, v199
    v_accvgpr_write_b32 a112, v184
    v_accvgpr_write_b32 a113, v185
    v_accvgpr_write_b32 a114, v186
    v_accvgpr_write_b32 a115, v187
    v_accvgpr_read_b32 v184, a0
    v_accvgpr_read_b32 v185, a1
    v_accvgpr_read_b32 v186, a2
    v_accvgpr_read_b32 v187, a3
    v_accvgpr_read_b32 v188, a4
    v_accvgpr_read_b32 v189, a5
    v_accvgpr_read_b32 v190, a6
    v_accvgpr_read_b32 v191, a7
    v_pk_add_f32 v[184:185], v[184:185], v[0:1]
    v_pk_add_f32 v[186:187], v[186:187], v[2:3]
    v_pk_add_f32 v[188:189], v[188:189], v[4:5]
    v_pk_add_f32 v[190:191], v[190:191], v[6:7]
    v_pk_mul_f32 v[184:185], v[184:185], v[202:203] op_sel:[0,1] op_sel_hi:[1,1]
    v_pk_mul_f32 v[186:187], v[186:187], v[202:203] op_sel:[0,1] op_sel_hi:[1,1]
    v_pk_mul_f32 v[188:189], v[188:189], v[202:203] op_sel:[0,1] op_sel_hi:[1,1]
    v_pk_mul_f32 v[190:191], v[190:191], v[202:203] op_sel:[0,1] op_sel_hi:[1,1]
    v_permlane16_swap_b32 v192, v194
    v_permlane16_swap_b32 v193, v195
    v_cvt_pk_bf16_f32 v184, v184, v185
    v_cvt_pk_bf16_f32 v185, v186, v187
    v_cvt_pk_bf16_f32 v186, v188, v189
    v_cvt_pk_bf16_f32 v187, v190, v191
    buffer_store_dwordx4 v[192:195], v244, s[20:23], s34 offen offset:320 sc1
    v_mov_b32 v249, 0
    v_mov_b32 v250, 0
    v_mov_b32 v251, 0
    v_mov_b32 v252, 0
    v_accvgpr_read_b32 v192, a8
    v_accvgpr_read_b32 v193, a9
    v_accvgpr_read_b32 v194, a10
    v_accvgpr_read_b32 v195, a11
    v_accvgpr_read_b32 v196, a12
    v_accvgpr_read_b32 v197, a13
    v_accvgpr_read_b32 v198, a14
    v_accvgpr_read_b32 v199, a15
    v_pk_add_f32 v[192:193], v[192:193], v[8:9]
    v_pk_add_f32 v[194:195], v[194:195], v[10:11]
    v_pk_add_f32 v[196:197], v[196:197], v[12:13]
    v_pk_add_f32 v[198:199], v[198:199], v[14:15]
    v_pk_mul_f32 v[192:193], v[192:193], v[202:203] op_sel:[0,1] op_sel_hi:[1,1]
    v_pk_mul_f32 v[194:195], v[194:195], v[202:203] op_sel:[0,1] op_sel_hi:[1,1]
    v_pk_mul_f32 v[196:197], v[196:197], v[202:203] op_sel:[0,1] op_sel_hi:[1,1]
    v_pk_mul_f32 v[198:199], v[198:199], v[202:203] op_sel:[0,1] op_sel_hi:[1,1]
    v_permlane16_swap_b32 v184, v186
    v_permlane16_swap_b32 v185, v187
    v_cvt_pk_bf16_f32 v192, v192, v193
    v_cvt_pk_bf16_f32 v193, v194, v195
    v_mfma_f32_32x32x16_bf16 a[0:15], v[212:215], v[212:215], 0
    v_cvt_pk_bf16_f32 v194, v196, v197
    v_cvt_pk_bf16_f32 v195, v198, v199
    v_accvgpr_write_b32 a120, v184
    v_accvgpr_write_b32 a121, v185
    v_accvgpr_write_b32 a122, v186
    v_accvgpr_write_b32 a123, v187
    v_accvgpr_read_b32 v184, a16
    v_accvgpr_read_b32 v185, a17
    v_accvgpr_read_b32 v186, a18
    v_accvgpr_read_b32 v187, a19
    v_accvgpr_read_b32 v188, a20
    v_accvgpr_read_b32 v189, a21
    v_accvgpr_read_b32 v190, a22
    v_accvgpr_read_b32 v191, a23
    v_pk_add_f32 v[184:185], v[184:185], v[16:17]
    v_pk_add_f32 v[186:187], v[186:187], v[18:19]
    v_pk_add_f32 v[188:189], v[188:189], v[20:21]
    v_pk_add_f32 v[190:191], v[190:191], v[22:23]
    v_pk_mul_f32 v[184:185], v[184:185], v[202:203] op_sel:[0,1] op_sel_hi:[1,1]
    v_pk_mul_f32 v[186:187], v[186:187], v[202:203] op_sel:[0,1] op_sel_hi:[1,1]
    v_pk_mul_f32 v[188:189], v[188:189], v[202:203] op_sel:[0,1] op_sel_hi:[1,1]
    v_pk_mul_f32 v[190:191], v[190:191], v[202:203] op_sel:[0,1] op_sel_hi:[1,1]
    v_permlane16_swap_b32 v192, v194
    v_permlane16_swap_b32 v193, v195
    v_cvt_pk_bf16_f32 v184, v184, v185
    v_cvt_pk_bf16_f32 v185, v186, v187
    v_mfma_f32_32x32x16_bf16 a[16:31], v[212:215], v[212:215], 0
    v_cvt_pk_bf16_f32 v186, v188, v189
    v_cvt_pk_bf16_f32 v187, v190, v191
    v_accvgpr_write_b32 a124, v192
    v_accvgpr_write_b32 a125, v193
    v_accvgpr_write_b32 a126, v194
    v_accvgpr_write_b32 a127, v195
    v_mfma_f32_32x32x16_bf16 v[0:15], v[212:215], v[212:215], 0
    v_permlane16_swap_b32 v184, v186
    v_permlane16_swap_b32 v185, v187
    v_accvgpr_write_b32 a128, v184
    v_accvgpr_write_b32 a129, v185
    v_accvgpr_write_b32 a130, v186
    v_accvgpr_write_b32 a131, v187
    v_mfma_f32_32x32x16_bf16 v[16:31], v[212:215], v[212:215], 0
    s_setpc_b64 s[62:63]
L_slow:
    s_mul_i32 s99, s3, 36864
    s_sub_u32 s50, s99, s39
    v_add_u32 v236, s50, v236
    v_add_u32 v237, s50, v237
    v_add_u32 v238, s50, v238
    v_add_u32 v239, s50, v239
    v_add_u32 v240, s50, v240
    v_add_u32 v241, s50, v241
    s_mov_b32 s97, 0
L_slow_tile:
    s_cmp_lt_u32 s97, 4
    s_cselect_b32 s64, s12, s16
    s_cselect_b32 s68, s20, s24
    s_cselect_b32 s65, s13, s17
    s_cselect_b32 s69, s21, s25
    s_cselect_b32 s96, 0, 393216
    s_cselect_b32 s51, s46, s47
    s_mov_b32 s66, 165888
    s_mov_b32 s67, 0x20000
    s_mov_b32 s70, 165888
    s_mov_b32 s71, 0x20000
    s_and_b32 s52, s97, 3
    s_mul_i32 s53, s52, 6144
    s_add_u32 s95, s32, s53
    s_cmp_eq_u32 s52, 3
    s_cselect_b32 s95, s35, s95
    s_cmp_eq_u32 s51, 0
    s_cbranch_scc1 L_slow_next
    buffer_load_dwordx4 v[0:3], v243, s[64:67], s95 offen offset:0
    buffer_load_dwordx4 v[4:7], v243, s[64:67], s95 offen offset:64
    buffer_load_dwordx4 v[8:11], v243, s[64:67], s95 offen offset:128
    buffer_load_dwordx4 v[12:15], v243, s[64:67], s95 offen offset:192
    buffer_load_dwordx4 v[16:19], v243, s[64:67], s95 offen offset:256
    buffer_load_dwordx4 v[20:23], v243, s[64:67], s95 offen offset:320
    v_mov_b32 v137, 0xff800000
    v_mov_b32 v136, 0
    v_mov_b32 v32, 0
    v_mov_b32 v33, 0
    v_mov_b32 v34, 0
    v_mov_b32 v35, 0
    v_mov_b32 v36, 0
    v_mov_b32 v37, 0
    v_mov_b32 v38, 0
    v_mov_b32 v39, 0
    v_mov_b32 v40, 0
    v_mov_b32 v41, 0
    v_mov_b32 v42, 0
    v_mov_b32 v43, 0
    v_mov_b32 v44, 0
    v_mov_b32 v45, 0
    v_mov_b32 v46, 0
    v_mov_b32 v47, 0
    v_mov_b32 v48, 0
    v_mov_b32 v49, 0
    v_mov_b32 v50, 0
    v_mov_b32 v51, 0
    v_mov_b32 v52, 0
    v_mov_b32 v53, 0
    v_mov_b32 v54, 0
    v_mov_b32 v55, 0
    v_mov_b32 v56, 0
    v_mov_b32 v57, 0
    v_mov_b32 v58, 0
    v_mov_b32 v59, 0
    v_mov_b32 v60, 0
    v_mov_b32 v61, 0
    v_mov_b32 v62, 0
    v_mov_b32 v63, 0
    v_mov_b32 v64, 0
    v_mov_b32 v65, 0
    v_mov_b32 v66, 0
    v_mov_b32 v67, 0
    v_mov_b32 v68, 0
    v_mov_b32 v69, 0
    v_mov_b32 v70, 0
    v_mov_b32 v71, 0
    v_mov_b32 v72, 0
    v_mov_b32 v73, 0
    v_mov_b32 v74, 0
    v_mov_b32 v75, 0
    v_mov_b32 v76, 0
    v_mov_b32 v77, 0
    v_mov_b32 v78, 0
    v_mov_b32 v79, 0
    s_waitcnt vmcnt(0)
    v_lshlrev_b32 v152, 16, v0
    v_lshlrev_b32 v153, 16, v1
    v_lshlrev_b32 v154, 16, v2
    v_lshlrev_b32 v155, 16, v3
    v_and_b32 v156, 0xffff0000, v0
    v_and_b32 v157, 0xffff0000, v1
    v_and_b32 v158, 0xffff0000, v2
    v_and_b32 v159, 0xffff0000, v3
    v_mul_f32 v152, s44, v152
    v_mul_f32 v153, s44, v153
    v_mul_f32 v154, s44, v154
    v_mul_f32 v155, s44, v155
    v_mul_f32 v156, s44, v156
    v_mul_f32 v157, s44, v157
    v_mul_f32 v158, s44, v158
    v_mul_f32 v159, s44, v159
    v_cvt_pk_bf16_f32 v0, v152, v156
    v_cvt_pk_bf16_f32 v1, v153, v157
    v_cvt_pk_bf16_f32 v2, v154, v158
    v_cvt_pk_bf16_f32 v3, v155, v159
    v_lshlrev_b32 v152, 16, v4
    v_lshlrev_b32 v153, 16, v5
    v_lshlrev_b32 v154, 16, v6
    v_lshlrev_b32 v155, 16, v7
    v_and_b32 v156, 0xffff0000, v4
    v_and_b32 v157, 0xffff0000, v5
    v_and_b32 v158, 0xffff0000, v6
    v_and_b32 v159, 0xffff0000, v7
    v_mul_f32 v152, s44, v152
    v_mul_f32 v153, s44, v153
    v_mul_f32 v154, s44, v154
    v_mul_f32 v155, s44, v155
    v_mul_f32 v156, s44, v156
    v_mul_f32 v157, s44, v157
    v_mul_f32 v158, s44, v158
    v_mul_f32 v159, s44, v159
    v_cvt_pk_bf16_f32 v4, v152, v156
    v_cvt_pk_bf16_f32 v5, v153, v157
    v_cvt_pk_bf16_f32 v6, v154, v158
    v_cvt_pk_bf16_f32 v7, v155, v159
    v_lshlrev_b32 v152, 16, v8
    v_lshlrev_b32 v153, 16, v9
    v_lshlrev_b32 v154, 16, v10
    v_lshlrev_b32 v155, 16, v11
    v_and_b32 v156, 0xffff0000, v8
    v_and_b32 v157, 0xffff0000, v9
    v_and_b32 v158, 0xffff0000, v10
    v_and_b32 v159, 0xffff0000, v11
    v_mul_f32 v152, s44, v152
    v_mul_f32 v153, s44, v153
    v_mul_f32 v154, s44, v154
    v_mul_f32 v155, s44, v155
    v_mul_f32 v156, s44, v156
    v_mul_f32 v157, s44, v157
    v_mul_f32 v158, s44, v158
    v_mul_f32 v159, s44, v159
    v_cvt_pk_bf16_f32 v8, v152, v156
    v_cvt_pk_bf16_f32 v9, v153, v157
    v_cvt_pk_bf16_f32 v10, v154, v158
    v_cvt_pk_bf16_f32 v11, v155, v159
    v_lshlrev_b32 v152, 16, v12
    v_lshlrev_b32 v153, 16, v13
    v_lshlrev_b32 v154, 16, v14
    v_lshlrev_b32 v155, 16, v15
    v_and_b32 v156, 0xffff0000, v12
    v_and_b32 v157, 0xffff0000, v13
    v_and_b32 v158, 0xffff0000, v14
    v_and_b32 v159, 0xffff0000, v15
    v_mul_f32 v152, s44, v152
    v_mul_f32 v153, s44, v153
    v_mul_f32 v154, s44, v154
    v_mul_f32 v155, s44, v155
    v_mul_f32 v156, s44, v156
    v_mul_f32 v157, s44, v157
    v_mul_f32 v158, s44, v158
    v_mul_f32 v159, s44, v159
    v_cvt_pk_bf16_f32 v12, v152, v156
    v_cvt_pk_bf16_f32 v13, v153, v157
    v_cvt_pk_bf16_f32 v14, v154, v158
    v_cvt_pk_bf16_f32 v15, v155, v159
    v_lshlrev_b32 v152, 16, v16
    v_lshlrev_b32 v153, 16, v17
    v_lshlrev_b32 v154, 16, v18
    v_lshlrev_b32 v155, 16, v19
    v_and_b32 v156, 0xffff0000, v16
    v_and_b32 v157, 0xffff0000, v17
    v_and_b32 v158, 0xffff0000, v18
    v_and_b32 v159, 0xffff0000, v19
    v_mul_f32 v152, s44, v152
    v_mul_f32 v153, s44, v153
    v_mul_f32 v154, s44, v154
    v_mul_f32 v155, s44, v155
    v_mul_f32 v156, s44, v156
    v_mul_f32 v157, s44, v157
    v_mul_f32 v158, s44, v158
    v_mul_f32 v159, s44, v159
    v_cvt_pk_bf16_f32 v16, v152, v156
    v_cvt_pk_bf16_f32 v17, v153, v157
    v_cvt_pk_bf16_f32 v18, v154, v158
    v_cvt_pk_bf16_f32 v19, v155, v159
    v_lshlrev_b32 v152, 16, v20
    v_lshlrev_b32 v153, 16, v21
    v_lshlrev_b32 v154, 16, v22
    v_lshlrev_b32 v155, 16, v23
    v_and_b32 v156, 0xffff0000, v20
    v_and_b32 v157, 0xffff0000, v21
    v_and_b32 v158, 0xffff0000, v22
    v_and_b32 v159, 0xffff0000, v23
    v_mul_f32 v152, s44, v152
    v_mul_f32 v153, s44, v153
    v_mul_f32 v154, s44, v154
    v_mul_f32 v155, s44, v155
    v_mul_f32 v156, s44, v156
    v_mul_f32 v157, s44, v157
    v_mul_f32 v158, s44, v158
    v_mul_f32 v159, s44, v159
    v_cvt_pk_bf16_f32 v20, v152, v156
    v_cvt_pk_bf16_f32 v21, v153, v157
    v_cvt_pk_bf16_f32 v22, v154, v158
    v_cvt_pk_bf16_f32 v23, v155, v159
    s_mov_b32 s98, 32
    s_mov_b32 s100, s96
L_slow_kv:
    s_add_u32 s53, s100, 0
    s_add_u32 m0, s99, 0
    s_nop 0
    buffer_load_dwordx4 v242, s[4:7], s53 offen offset:0 lds
    s_add_u32 m0, s99, 0
    s_nop 0
    buffer_load_dwordx4 v246, s[4:7], s53 offen offset:1024 lds
    s_add_u32 m0, s99, 0
    s_nop 0
    buffer_load_dwordx4 v253, s[4:7], s53 offen offset:2048 lds
    s_add_u32 s53, s100, 3072
    s_add_u32 m0, s99, 3072
    s_nop 0
    buffer_load_dwordx4 v242, s[4:7], s53 offen offset:0 lds
    s_add_u32 m0, s99, 3072
    s_nop 0
    buffer_load_dwordx4 v246, s[4:7], s53 offen offset:1024 lds
    s_add_u32 m0, s99, 3072
    s_nop 0
    buffer_load_dwordx4 v253, s[4:7], s53 offen offset:2048 lds
    s_add_u32 s53, s100, 6144
    s_add_u32 m0, s99, 6144
    s_nop 0
    buffer_load_dwordx4 v242, s[4:7], s53 offen offset:0 lds
    s_add_u32 m0, s99, 6144
    s_nop 0
    buffer_load_dwordx4 v246, s[4:7], s53 offen offset:1024 lds
    s_add_u32 m0, s99, 6144
    s_nop 0
    buffer_load_dwordx4 v253, s[4:7], s53 offen offset:2048 lds
    s_add_u32 s53, s100, 9216
    s_add_u32 m0, s99, 9216
    s_nop 0
    buffer_load_dwordx4 v242, s[4:7], s53 offen offset:0 lds
    s_add_u32 m0, s99, 9216
    s_nop 0
    buffer_load_dwordx4 v246, s[4:7], s53 offen offset:1024 lds
    s_add_u32 m0, s99, 9216
    s_nop 0
    buffer_load_dwordx4 v253, s[4:7], s53 offen offset:2048 lds
    s_add_u32 s53, s100, 0
    s_add_u32 m0, s99, 12288
    s_nop 0
    buffer_load_dwordx4 v242, s[8:11], s53 offen offset:0 lds
    s_add_u32 m0, s99, 12288
    s_nop 0
    buffer_load_dwordx4 v246, s[8:11], s53 offen offset:1024 lds
    s_add_u32 m0, s99, 12288
    s_nop 0
    buffer_load_dwordx4 v253, s[8:11], s53 offen offset:2048 lds
    s_add_u32 s53, s100, 3072
    s_add_u32 m0, s99, 15360
    s_nop 0
    buffer_load_dwordx4 v242, s[8:11], s53 offen offset:0 lds
    s_add_u32 m0, s99, 15360
    s_nop 0
    buffer_load_dwordx4 v246, s[8:11], s53 offen offset:1024 lds
    s_add_u32 m0, s99, 15360
    s_nop 0
    buffer_load_dwordx4 v253, s[8:11], s53 offen offset:2048 lds
    s_add_u32 s53, s100, 6144
    s_add_u32 m0, s99, 18432
    s_nop 0
    buffer_load_dwordx4 v242, s[8:11], s53 offen offset:0 lds
    s_add_u32 m0, s99, 18432
    s_nop 0
    buffer_load_dwordx4 v246, s[8:11], s53 offen offset:1024 lds
    s_add_u32 m0, s99, 18432
    s_nop 0
    buffer_load_dwordx4 v253, s[8:11], s53 offen offset:2048 lds
    s_add_u32 s53, s100, 9216
    s_add_u32 m0, s99, 21504
    s_nop 0
    buffer_load_dwordx4 v242, s[8:11], s53 offen offset:0 lds
    s_add_u32 m0, s99, 21504
    s_nop 0
    buffer_load_dwordx4 v246, s[8:11], s53 offen offset:1024 lds
    s_add_u32 m0, s99, 21504
    s_nop 0
    buffer_load_dwordx4 v253, s[8:11], s53 offen offset:2048 lds
    s_waitcnt vmcnt(0)
    ds_read_b128 v[80:83], v236 offset:0
    ds_read_b128 v[84:87], v237 offset:0
    ds_read_b128 v[88:91], v236 offset:128
    ds_read_b128 v[92:95], v237 offset:128
    ds_read_b128 v[96:99], v236 offset:256
    ds_read_b128 v[100:103], v237 offset:256
    ds_read_b128 v[104:107], v236 offset:6144
    ds_read_b128 v[108:111], v237 offset:6144
    ds_read_b128 v[112:115], v236 offset:6272
    ds_read_b128 v[116:119], v237 offset:6272
    ds_read_b128 v[120:123], v236 offset:6400
    ds_read_b128 v[124:127], v237 offset:6400
    s_waitcnt lgkmcnt(0)
    v_mfma_f32_16x16x32_bf16 v[128:131], v[80:83], v[0:3], 0
    v_mfma_f32_16x16x32_bf16 v[128:131], v[84:87], v[4:7], v[128:131]
    v_mfma_f32_16x16x32_bf16 v[128:131], v[88:91], v[8:11], v[128:131]
    v_mfma_f32_16x16x32_bf16 v[128:131], v[92:95], v[12:15], v[128:131]
    v_mfma_f32_16x16x32_bf16 v[128:131], v[96:99], v[16:19], v[128:131]
    v_mfma_f32_16x16x32_bf16 v[128:131], v[100:103], v[20:23], v[128:131]
    v_mfma_f32_16x16x32_bf16 v[132:135], v[104:107], v[0:3], 0
    v_mfma_f32_16x16x32_bf16 v[132:135], v[108:111], v[4:7], v[132:135]
    v_mfma_f32_16x16x32_bf16 v[132:135], v[112:115], v[8:11], v[132:135]
    v_mfma_f32_16x16x32_bf16 v[132:135], v[116:119], v[12:15], v[132:135]
    v_mfma_f32_16x16x32_bf16 v[132:135], v[120:123], v[16:19], v[132:135]
    v_mfma_f32_16x16x32_bf16 v[132:135], v[124:127], v[20:23], v[132:135]
    s_nop 1
    v_max3_f32 v138, v128, v129, v130
    s_nop 4
    v_max3_f32 v138, v138, v131, v132
    v_max3_f32 v138, v138, v133, v134
    v_max3_f32 v138, v138, v135, v137
    v_mov_b32 v139, v138
    s_nop 1
    v_permlane32_swap_b32 v138, v139
    v_max_f32 v138, v138, v139
    v_mov_b32 v139, v138
    s_nop 1
    v_permlane16_swap_b32 v138, v139
    v_max_f32 v138, v138, v139
    v_sub_f32 v140, v137, v138
    v_exp_f32 v140, v140
    v_mov_b32 v137, v138
    ds_read_b64_tr_b16 v[80:81], v238 offset:12288
    ds_read_b64_tr_b16 v[82:83], v238 offset:18432
    ds_read_b64_tr_b16 v[84:85], v239 offset:12288
    ds_read_b64_tr_b16 v[86:87], v239 offset:18432
    ds_read_b64_tr_b16 v[88:89], v240 offset:12288
    ds_read_b64_tr_b16 v[90:91], v240 offset:18432
    ds_read_b64_tr_b16 v[92:93], v241 offset:12288
    ds_read_b64_tr_b16 v[94:95], v241 offset:18432
    ds_read_b64_tr_b16 v[96:97], v238 offset:12416
    ds_read_b64_tr_b16 v[98:99], v238 offset:18560
    ds_read_b64_tr_b16 v[100:101], v239 offset:12416
    ds_read_b64_tr_b16 v[102:103], v239 offset:18560
    ds_read_b64_tr_b16 v[104:105], v240 offset:12416
    ds_read_b64_tr_b16 v[106:107], v240 offset:18560
    ds_read_b64_tr_b16 v[108:109], v241 offset:12416
    ds_read_b64_tr_b16 v[110:111], v241 offset:18560
    ds_read_b64_tr_b16 v[112:113], v238 offset:12544
    ds_read_b64_tr_b16 v[114:115], v238 offset:18688
    ds_read_b64_tr_b16 v[116:117], v239 offset:12544
    ds_read_b64_tr_b16 v[118:119], v239 offset:18688
    ds_read_b64_tr_b16 v[120:121], v240 offset:12544
    ds_read_b64_tr_b16 v[122:123], v240 offset:18688
    ds_read_b64_tr_b16 v[124:125], v241 offset:12544
    ds_read_b64_tr_b16 v[126:127], v241 offset:18688
    v_mul_f32 v136, v136, v140
    v_mul_f32 v32, v32, v140
    v_mul_f32 v33, v33, v140
    v_mul_f32 v34, v34, v140
    v_mul_f32 v35, v35, v140
    v_mul_f32 v36, v36, v140
    v_mul_f32 v37, v37, v140
    v_mul_f32 v38, v38, v140
    v_mul_f32 v39, v39, v140
    v_mul_f32 v40, v40, v140
    v_mul_f32 v41, v41, v140
    v_mul_f32 v42, v42, v140
    v_mul_f32 v43, v43, v140
    v_mul_f32 v44, v44, v140
    v_mul_f32 v45, v45, v140
    v_mul_f32 v46, v46, v140
    v_mul_f32 v47, v47, v140
    v_mul_f32 v48, v48, v140
    v_mul_f32 v49, v49, v140
    v_mul_f32 v50, v50, v140
    v_mul_f32 v51, v51, v140
    v_mul_f32 v52, v52, v140
    v_mul_f32 v53, v53, v140
    v_mul_f32 v54, v54, v140
    v_mul_f32 v55, v55, v140
    v_mul_f32 v56, v56, v140
    v_mul_f32 v57, v57, v140
    v_mul_f32 v58, v58, v140
    v_mul_f32 v59, v59, v140
    v_mul_f32 v60, v60, v140
    v_mul_f32 v61, v61, v140
    v_mul_f32 v62, v62, v140
    v_mul_f32 v63, v63, v140
    v_mul_f32 v64, v64, v140
    v_mul_f32 v65, v65, v140
    v_mul_f32 v66, v66, v140
    v_mul_f32 v67, v67, v140
    v_mul_f32 v68, v68, v140
    v_mul_f32 v69, v69, v140
    v_mul_f32 v70, v70, v140
    v_mul_f32 v71, v71, v140
    v_mul_f32 v72, v72, v140
    v_mul_f32 v73, v73, v140
    v_mul_f32 v74, v74, v140
    v_mul_f32 v75, v75, v140
    v_mul_f32 v76, v76, v140
    v_mul_f32 v77, v77, v140
    v_mul_f32 v78, v78, v140
    v_mul_f32 v79, v79, v140
    v_sub_f32 v128, v128, v137
    v_sub_f32 v129, v129, v137
    v_sub_f32 v130, v130, v137
    v_sub_f32 v131, v131, v137
    v_sub_f32 v132, v132, v137
    v_sub_f32 v133, v133, v137
    v_sub_f32 v134, v134, v137
    v_sub_f32 v135, v135, v137
    v_exp_f32 v128, v128
    v_exp_f32 v129, v129
    v_exp_f32 v130, v130
    v_exp_f32 v131, v131
    v_exp_f32 v132, v132
    v_exp_f32 v133, v133
    v_exp_f32 v134, v134
    v_exp_f32 v135, v135
    v_add_f32 v136, v136, v128
    v_add_f32 v136, v136, v129
    v_add_f32 v136, v136, v130
    v_add_f32 v136, v136, v131
    v_add_f32 v136, v136, v132
    v_add_f32 v136, v136, v133
    v_add_f32 v136, v136, v134
    v_add_f32 v136, v136, v135
    v_cvt_pk_bf16_f32 v128, v128, v129
    v_cvt_pk_bf16_f32 v129, v130, v131
    v_cvt_pk_bf16_f32 v130, v132, v133
    v_cvt_pk_bf16_f32 v131, v134, v135
    s_waitcnt lgkmcnt(0)
    s_nop 0
    v_mfma_f32_16x16x32_bf16 v[32:35], v[80:83], v[128:131], v[32:35]
    v_mfma_f32_16x16x32_bf16 v[36:39], v[84:87], v[128:131], v[36:39]
    v_mfma_f32_16x16x32_bf16 v[40:43], v[88:91], v[128:131], v[40:43]
    v_mfma_f32_16x16x32_bf16 v[44:47], v[92:95], v[128:131], v[44:47]
    v_mfma_f32_16x16x32_bf16 v[48:51], v[96:99], v[128:131], v[48:51]
    v_mfma_f32_16x16x32_bf16 v[52:55], v[100:103], v[128:131], v[52:55]
    v_mfma_f32_16x16x32_bf16 v[56:59], v[104:107], v[128:131], v[56:59]
    v_mfma_f32_16x16x32_bf16 v[60:63], v[108:111], v[128:131], v[60:63]
    v_mfma_f32_16x16x32_bf16 v[64:67], v[112:115], v[128:131], v[64:67]
    v_mfma_f32_16x16x32_bf16 v[68:71], v[116:119], v[128:131], v[68:71]
    v_mfma_f32_16x16x32_bf16 v[72:75], v[120:123], v[128:131], v[72:75]
    v_mfma_f32_16x16x32_bf16 v[76:79], v[124:127], v[128:131], v[76:79]
    s_add_u32 s100, s100, 12288
    s_sub_u32 s98, s98, 1
    s_cmp_lg_u32 s98, 0
    s_nop 7
    s_cbranch_scc1 L_slow_kv
    v_mov_b32 v139, v136
    s_nop 1
    v_permlane32_swap_b32 v136, v139
    v_add_f32 v136, v136, v139
    v_mov_b32 v139, v136
    s_nop 1
    v_permlane16_swap_b32 v136, v139
    v_add_f32 v136, v136, v139
    v_rcp_f32 v136, v136
    s_nop 0
    v_pk_mul_f32 v[152:153], v[32:33], v[136:137] op_sel_hi:[1,0]
    v_pk_mul_f32 v[154:155], v[34:35], v[136:137] op_sel_hi:[1,0]
    v_pk_mul_f32 v[156:157], v[36:37], v[136:137] op_sel_hi:[1,0]
    v_pk_mul_f32 v[158:159], v[38:39], v[136:137] op_sel_hi:[1,0]
    v_cvt_pk_bf16_f32 v80, v152, v153
    v_cvt_pk_bf16_f32 v81, v154, v155
    v_cvt_pk_bf16_f32 v82, v156, v157
    v_cvt_pk_bf16_f32 v83, v158, v159
    s_nop 0
    v_permlane16_swap_b32 v80, v82
    v_permlane16_swap_b32 v81, v83
    buffer_store_dwordx4 v[80:83], v244, s[68:71], s95 offen offset:0
    v_pk_mul_f32 v[152:153], v[40:41], v[136:137] op_sel_hi:[1,0]
    v_pk_mul_f32 v[154:155], v[42:43], v[136:137] op_sel_hi:[1,0]
    v_pk_mul_f32 v[156:157], v[44:45], v[136:137] op_sel_hi:[1,0]
    v_pk_mul_f32 v[158:159], v[46:47], v[136:137] op_sel_hi:[1,0]
    v_cvt_pk_bf16_f32 v84, v152, v153
    v_cvt_pk_bf16_f32 v85, v154, v155
    v_cvt_pk_bf16_f32 v86, v156, v157
    v_cvt_pk_bf16_f32 v87, v158, v159
    s_nop 0
    v_permlane16_swap_b32 v84, v86
    v_permlane16_swap_b32 v85, v87
    buffer_store_dwordx4 v[84:87], v244, s[68:71], s95 offen offset:64
    v_pk_mul_f32 v[152:153], v[48:49], v[136:137] op_sel_hi:[1,0]
    v_pk_mul_f32 v[154:155], v[50:51], v[136:137] op_sel_hi:[1,0]
    v_pk_mul_f32 v[156:157], v[52:53], v[136:137] op_sel_hi:[1,0]
    v_pk_mul_f32 v[158:159], v[54:55], v[136:137] op_sel_hi:[1,0]
    v_cvt_pk_bf16_f32 v88, v152, v153
    v_cvt_pk_bf16_f32 v89, v154, v155
    v_cvt_pk_bf16_f32 v90, v156, v157
    v_cvt_pk_bf16_f32 v91, v158, v159
    s_nop 0
    v_permlane16_swap_b32 v88, v90
    v_permlane16_swap_b32 v89, v91
    buffer_store_dwordx4 v[88:91], v244, s[68:71], s95 offen offset:128
    v_pk_mul_f32 v[152:153], v[56:57], v[136:137] op_sel_hi:[1,0]
    v_pk_mul_f32 v[154:155], v[58:59], v[136:137] op_sel_hi:[1,0]
    v_pk_mul_f32 v[156:157], v[60:61], v[136:137] op_sel_hi:[1,0]
    v_pk_mul_f32 v[158:159], v[62:63], v[136:137] op_sel_hi:[1,0]
    v_cvt_pk_bf16_f32 v92, v152, v153
    v_cvt_pk_bf16_f32 v93, v154, v155
    v_cvt_pk_bf16_f32 v94, v156, v157
    v_cvt_pk_bf16_f32 v95, v158, v159
    s_nop 0
    v_permlane16_swap_b32 v92, v94
    v_permlane16_swap_b32 v93, v95
    buffer_store_dwordx4 v[92:95], v244, s[68:71], s95 offen offset:192
    v_pk_mul_f32 v[152:153], v[64:65], v[136:137] op_sel_hi:[1,0]
    v_pk_mul_f32 v[154:155], v[66:67], v[136:137] op_sel_hi:[1,0]
    v_pk_mul_f32 v[156:157], v[68:69], v[136:137] op_sel_hi:[1,0]
    v_pk_mul_f32 v[158:159], v[70:71], v[136:137] op_sel_hi:[1,0]
    v_cvt_pk_bf16_f32 v96, v152, v153
    v_cvt_pk_bf16_f32 v97, v154, v155
    v_cvt_pk_bf16_f32 v98, v156, v157
    v_cvt_pk_bf16_f32 v99, v158, v159
    s_nop 0
    v_permlane16_swap_b32 v96, v98
    v_permlane16_swap_b32 v97, v99
    buffer_store_dwordx4 v[96:99], v244, s[68:71], s95 offen offset:256
    v_pk_mul_f32 v[152:153], v[72:73], v[136:137] op_sel_hi:[1,0]
    v_pk_mul_f32 v[154:155], v[74:75], v[136:137] op_sel_hi:[1,0]
    v_pk_mul_f32 v[156:157], v[76:77], v[136:137] op_sel_hi:[1,0]
    v_pk_mul_f32 v[158:159], v[78:79], v[136:137] op_sel_hi:[1,0]
    v_cvt_pk_bf16_f32 v100, v152, v153
    v_cvt_pk_bf16_f32 v101, v154, v155
    v_cvt_pk_bf16_f32 v102, v156, v157
    v_cvt_pk_bf16_f32 v103, v158, v159
    s_nop 0
    v_permlane16_swap_b32 v100, v102
    v_permlane16_swap_b32 v101, v103
    buffer_store_dwordx4 v[100:103], v244, s[68:71], s95 offen offset:320
    s_waitcnt vmcnt(0)
L_slow_next:
    s_add_u32 s97, s97, 1
    s_cmp_lt_u32 s97, 8
    s_cbranch_scc1 L_slow_tile
    s_endpgm
.section .rodata,"a"
.p2align 6
.amdhsa_kernel standalone__gqa_softmax__near_ridge_kernel
  .amdhsa_next_free_vgpr 512
  .amdhsa_next_free_sgpr 102
  .amdhsa_accum_offset 256
  .amdhsa_group_segment_fixed_size 0
  .amdhsa_kernarg_size 48
  .amdhsa_user_sgpr_count 2
  .amdhsa_user_sgpr_kernarg_segment_ptr 1
  .amdhsa_system_sgpr_workgroup_id_x 1
.end_amdhsa_kernel
```
